```python
import torch

def _softmax(x, axis=-1):
    return torch.softmax(x, dim=axis)

def _gelu(x):
    return torch.nn.functional.gelu(x, approximate='tanh')

def _silu(x):
    return torch.nn.functional.silu(x)

def _sigmoid(x):
    return torch.sigmoid(x)

def _layernorm(x, axis=-1, eps=1e-05):
    m = x.mean(dim=axis, keepdim=True)
    v = x.var(dim=axis, keepdim=True, unbiased=False)
    return (x - m) / torch.sqrt(v + eps)

def _scatter_add(tgt, idx, src, axis=0):
    return tgt.clone().index_add_(axis, idx, src)

def _segment_sum(src, seg, n):
    out = torch.zeros((n,) + src.shape[1:], dtype=src.dtype)
    return out.index_add_(0, seg, src)

def _pad(x, pw):
    flat = tuple((v for pair in reversed(pw) for v in pair))
    return torch.nn.functional.pad(x, flat)
kernel_name = 'adaLN_cond__ssm_conv_h3__moe_arch_mod__prompt'

def setup_inputs():

    _w = lambda a: (lambda t: t.to(torch.bfloat16) if t.is_floating_point() else t)(torch.as_tensor(a))

    def _A_setup():
        B, S, D = (1, 2048, 512)
        ks = 4
        return {'q': _w((lambda *s: torch.randn(*s, dtype=torch.bfloat16) * 0.1)(B, S, D)), 'k': _w((lambda *s: torch.randn(*s, dtype=torch.bfloat16) * 3.2)(B, S, D)), 'v': _w((lambda *s: torch.randn(*s, dtype=torch.bfloat16) * 3.2)(B, S, D)), 'shift_k': _w((lambda *s: torch.randn(*s, dtype=torch.bfloat16) * 3.2)(D, ks) * 0.5), 'ssm_k': _w((lambda *s: torch.randn(*s, dtype=torch.bfloat16) * 3.2)(D, S) * (1.0 / S ** 0.5)), 'ssm_D': _w((lambda *s: torch.randn(*s, dtype=torch.bfloat16) * 3.2)(D))}
    _A_in = _A_setup()

    def _B_setup():
        B, S, D, F, C = (1, 2048, 512, 1792, 8)
        return {'x': _w((lambda *s: torch.randn(*s, dtype=torch.bfloat16) * 0.1)(B, S, D)), 'w_r': _w((lambda *s: torch.randn(*s, dtype=torch.bfloat16) * 0.4)(D)), 'w_gate': _w((lambda *s: torch.randn(*s, dtype=torch.bfloat16) * 0.4)(D, F)), 'w_up': _w((lambda *s: torch.randn(*s, dtype=torch.bfloat16) * 0.4)(D, F)), 'w_down': _w((lambda *s: torch.randn(*s, dtype=torch.bfloat16) * 0.4)(F, D))}
    _B_in = _B_setup()
    return {'A_q': _A_in['q'], 'A_k': _A_in['k'], 'A_v': _A_in['v'], 'A_shift_k': _A_in['shift_k'], 'A_ssm_k': _A_in['ssm_k'], 'A_ssm_D': _A_in['ssm_D'], 'B_x': _B_in['x'], 'B_w_r': _B_in['w_r'], 'B_w_gate': _B_in['w_gate'], 'B_w_up': _B_in['w_up'], 'B_w_down': _B_in['w_down'], 'c': _w((lambda *s: torch.randn(*s, dtype=torch.bfloat16) * 0.2)(1, 512) * 8.0), 'w_mod': _w((lambda *s: torch.randn(*s, dtype=torch.bfloat16) * 0.2)(512, 6 * 512) * 512 ** (-0.5) * 8.0)}

def reference(A_q, A_k, A_v, A_shift_k, A_ssm_k, A_ssm_D, B_x, B_w_r, B_w_gate, B_w_up, B_w_down, c, w_mod):

    def _A_ref(q, k, v, shift_k, ssm_k, ssm_D):
        B, S, D = q.shape
        ks = shift_k.shape[-1]
        k_pad = _pad(k, ((0, 0), (ks - 1, 0), (0, 0)))
        k_shift = torch.zeros_like(k)
        for t in range(ks):
            k_shift = k_shift + k_pad[:, t:t + S, :] * shift_k[:, ks - 1 - t][None, None, :]
        kv = k_shift * v
        L = 2 * S
        kv_pad = _pad(kv, ((0, 0), (0, S), (0, 0)))
        kf_pad = _pad(ssm_k, ((0, 0), (0, S)))
        kv_f = (lambda x, axes=(-2, -1): torch.fft.rfft2(x.float(), dim=axes))(kv_pad[:, None, :, :], axes=(1, 2))
        kf_f = (lambda x, axes=(-2, -1): torch.fft.rfft2(x.float(), dim=axes))(kf_pad[:, None, :], axes=(1, 2))
        kf_f = (lambda x, *d: x.permute(*d))(kf_f, 1, 2, 0)
        y_f = kv_f * kf_f[None, :, :, :]
        y = (lambda x, s, axes=(-2, -1): torch.fft.irfft2(x, s=s, dim=axes).to(torch.bfloat16))(y_f, (1, L), axes=(1, 2))[:, 0, :S, :]
        y = y + kv * ssm_D[None, None, :]
        return q * y

    def _B_ref(x, w_r, w_gate, w_up, w_down):
        B, S, D = x.shape
        C = 8
        r = x @ w_r
        idx = torch.argsort(-r, axis=-1)[:, :C]
        idx_e = (lambda x, n, axis: torch.repeat_interleave(x, n, dim=axis))(idx.reshape(B, C, 1), D, axis=2)
        x_sel = (lambda x, i, axis: torch.take_along_dim(x, i, dim=axis))(x, idx_e, axis=1)
        g = _silu(x_sel @ w_gate)
        u = x_sel @ w_up
        y = g * u @ w_down
        r_sel = _sigmoid((lambda x, i, axis: torch.take_along_dim(x, i, dim=axis))(r, idx, axis=1))
        y = y * r_sel.reshape(B, C, 1)
        b_off = (torch.arange(B) * S).reshape(B, 1)
        flat_idx = (idx + b_off).reshape(B * C)
        zero = (x * 0.0).reshape(B * S, D)
        upd = _scatter_add(zero, flat_idx, y.reshape(B * C, D), axis=0)
        return x + upd.reshape(B, S, D)
    x = A_q
    mod = (_silu(c) @ w_mod).reshape(c.shape[0], 6, 1, -1)
    sa, ca, ga, sb, cb, gb = (mod[:, 0].clone(), mod[:, 1].clone(), mod[:, 2].clone(), mod[:, 3].clone(), mod[:, 4].clone(), mod[:, 5].clone())
    h = _layernorm(x, axis=-1) * (1 + ca) + sa
    x = x + ga * _A_ref(h, A_k, A_v, A_shift_k, A_ssm_k, A_ssm_D)
    h = _layernorm(x, axis=-1) * (1 + cb) + sb
    x = x + gb * _B_ref(h, B_w_r, B_w_gate, B_w_up, B_w_down)
    return x
```

```asm
; @launch grid=(256,1,1) block=(512,1,1) lds=158720
.amdgcn_target "amdgcn-amd-amdhsa--gfx950"
.text
.globl adaLN_cond__ssm_conv_h3__moe_arch_mod__prompt_kernel
.p2align 8
.type adaLN_cond__ssm_conv_h3__moe_arch_mod__prompt_kernel,@function
adaLN_cond__ssm_conv_h3__moe_arch_mod__prompt_kernel:
    s_cmp_ge_u32 s2, 256
    s_cbranch_scc1 L_end
    s_load_dwordx16 s[4:19], s[0:1], 0
    s_load_dwordx16 s[20:35], s[0:1], 64
    s_getreg_b32 s41, hwreg(HW_REG_XCC_ID)
    s_and_b32 s36, s2, 7
    s_lshr_b32 s37, s2, 3
    v_lshrrev_b32 v4, 6, v0
    v_and_b32 v1, 63, v0
    v_readfirstlane_b32 s38, v4
    s_and_b32 s41, s41, 15
    s_mov_b32 s52, 0xffff0000
    s_mov_b32 s42, 1000000
    s_lshl_b32 s56, s37, 16
    s_lshl_b32 s57, s36, 7
    s_add_u32 s43, s56, s57
    s_lshl_b32 s53, s36, 5
    s_add_u32 s53, s53, s37
    v_and_b32 v4, 31, v0
    v_lshrrev_b32 v5, 5, v0
    v_lshlrev_b32 v2, 12, v5
    v_lshl_add_u32 v2, v4, 2, v2
    v_add_u32 v2, s43, v2
    v_subrev_u32 v3, 0xc00, v2
    v_bfrev_b32 v6, 1
    v_cmp_gt_u32 vcc, 0xc00, v2
    s_nop 1
    v_cndmask_b32 v3, v3, v6, vcc
    v_lshl_add_u32 v6, v4, 4, s57
    v_lshl_add_u32 v6, s57, 1, v6
    v_add_u32 v6, s57, v6
    s_add_u32 s59, s41, 1
    v_mov_b32 v40, s53
    v_mov_b32 v41, s59
    s_lshl_b32 s60, s36, 7
    s_lshl_b32 s61, s37, 2
    s_add_u32 s60, s60, s61
    v_lshlrev_b32 v4, 4, v0
    v_subrev_u32 v5, 16, v4
    v_and_b32 v7, 255, v0
    v_cmp_eq_u32 vcc, 0, v7
    v_bfrev_b32 v7, 1
    s_nop 0
    v_cndmask_b32 v5, v5, v7, vcc
    s_lshl_b32 s56, s53, 13
    s_waitcnt lgkmcnt(0)
    s_load_dword s54, s[34:35], 0
    global_load_dwordx4 v[26:29], v6, s[10:11]
    global_load_dword v17, v2, s[6:7] offset:0
    global_load_dword v18, v2, s[6:7] offset:1024
    global_load_dword v19, v2, s[6:7] offset:2048
    global_load_dword v20, v2, s[6:7] offset:3072
    s_mov_b32 s44, s6
    s_mov_b32 s45, s7
    s_mov_b32 s46, 0x200000
    s_mov_b32 s47, 0x20000
    s_mov_b32 exec_hi, 0
    buffer_load_dword v14, v3, s[44:47], 0 offen offset:0
    buffer_load_dword v15, v3, s[44:47], 0 offen offset:1024
    buffer_load_dword v16, v3, s[44:47], 0 offen offset:2048
    s_mov_b64 exec, -1
    global_load_dword v21, v2, s[8:9] offset:0
    global_load_dword v22, v2, s[8:9] offset:1024
    global_load_dword v23, v2, s[8:9] offset:2048
    global_load_dword v24, v2, s[8:9] offset:3072
    s_add_u32 s34, s34, 0
    s_addc_u32 s35, s35, 0
    s_mov_b32 s64, s34
    s_mov_b32 s65, s35
    s_mov_b32 s66, 0x4000000
    s_mov_b32 s67, 0x20000
    s_mov_b32 s68, s30
    s_mov_b32 s69, s31
    s_mov_b32 s70, 0x200000
    s_mov_b32 s71, 0x20000
    s_add_u32 s48, s12, s56
    s_addc_u32 s49, s13, 0
    s_mov_b32 s50, 8192
    s_mov_b32 s51, 0x20000
    s_load_dword s55, s[14:15], s60
    s_cmp_lg_u32 s38, 7
    s_cbranch_scc1 L_nopt
    s_lshr_b32 s56, s37, 2
    s_lshl_b32 s56, s56, 7
    s_lshl_b32 s57, s36, 10
    s_add_u32 s56, s56, s57
    s_add_u32 s57, s56, 65536
    v_mov_b32 v42, s57
    s_add_u32 s57, s56, 73728
    v_writelane_b32 v42, s57, 2
    v_writelane_b32 v42, s57, 3
    s_lshl_b32 s56, s36, 7
    s_add_u32 s57, s56, 81920
    v_writelane_b32 v42, s57, 4
    v_writelane_b32 v42, s57, 5
    s_add_u32 s57, s56, 114688
    v_writelane_b32 v42, s57, 6
    v_writelane_b32 v42, s57, 7
    s_lshl_b32 s56, s53, 6
    s_and_b32 s56, s56, 0xffffff80
    s_add_u32 s57, s56, 98304
    v_writelane_b32 v42, s57, 8
    v_writelane_b32 v42, s57, 9
    v_and_b32 v43, 1, v0
    v_lshl_add_u32 v42, v43, 6, v42
    s_lshl_b32 s56, s53, 9
    s_add_u32 s57, s56, 260096
    v_lshl_add_u32 v43, v1, 6, s57
    v_cmp_lt_u32 vcc, 31, v1
    s_nop 1
    v_cndmask_b32 v42, v42, v43, vcc
    s_lshl_b32 s56, s37, 9
    s_add_u32 s57, s56, 161280
    v_lshl_add_u32 v43, v1, 6, s57
    v_cmp_lt_u32 vcc, 39, v1
    s_nop 1
    v_cndmask_b32 v42, v42, v43, vcc
    s_mov_b32 exec_lo, 0x3ff
    s_mov_b32 exec_hi, 0xff
    buffer_load_dword v43, v42, s[64:67], 0 offen sc1
    s_mov_b64 exec, 0xffff
    s_getpc_b64 s[56:57]
L_pc:
    s_lshl_b32 s58, s37, 10
    v_lshl_add_u32 v42, v1, 6, s58
    v_min_u32 v42, L_codeend-L_pc-4, v42
    global_load_dword v43, v42, s[56:57]
    s_mov_b64 exec, -1
L_nopt:
    v_mov_b32 v40, 3328
    v_mov_b32 v41, 0
    ds_write_b32 v40, v41
    v_and_b32 v6, 7, v0
    v_lshl_add_u32 v6, s38, 3, v6
    v_lshlrev_b32 v6, 10, v6
    v_lshrrev_b32 v7, 3, v1
    v_lshl_add_u32 v8, v7, 4, v6
    v_add_u32 v8, s43, v8
    s_barrier
    s_and_b32 s56, s37, 3
    s_lshl_b32 s56, s56, 8
    s_and_b32 s57, s38, 3
    s_lshl_b32 s57, s57, 6
    s_add_u32 s56, s56, s57
    v_and_b32 v6, 0x38, v0
    v_add_u32 v6, s56, v6
    global_load_dwordx2 v[44:45], v6, s[26:27]
    s_lshl_b32 s56, s36, 9
    s_add_u32 s56, s56, 90112
    v_and_b32 v40, 31, v0
    v_lshl_add_u32 v40, v40, 4, s56
    s_lshl_b32 s57, s37, 4
    s_add_u32 s56, s56, s57
    v_mov_b32 v41, s56
    s_waitcnt lgkmcnt(0)
    s_mul_i32 s39, s54, 0x9E3779B1
    s_add_u32 s39, s39, 0x7F4A7C15
    s_add_u32 s41, s41, s39
    s_add_u32 s41, s41, 1
    v_mov_b32 v42, s41
    s_cmp_lg_u32 s38, 0
    s_cbranch_scc1 L_nomode
    s_mov_b64 exec, 1
    buffer_store_dword v42, v41, s[64:67], 0 offen sc1
    s_mov_b64 exec, -1
L_nomode:
    s_mov_b32 s16, 0
    v_and_b32 v6, 31, v0
    v_lshrrev_b32 v7, 5, v0
    v_mul_u32_u24 v98, 272, v6
    v_lshlrev_b32 v7, 3, v7
    v_sub_u32 v98, v98, v7
    v_add_u32 v98, 17528, v98
    v_lshrrev_b32 v96, 4, v0
    v_mul_u32_u24 v99, 272, v96
    v_and_b32 v7, 15, v0
    v_lshl_add_u32 v99, v7, 4, v99
    v_lshlrev_b32 v96, 13, v96
    v_bfe_u32 v7, v0, 3, 1
    v_lshl_add_u32 v96, v7, 12, v96
    v_and_b32 v7, 7, v0
    v_lshl_add_u32 v96, v7, 4, v96
    s_lshl_b32 s56, s36, 18
    s_sub_u32 s57, 31, s37
    s_lshl_b32 s57, s57, 7
    s_add_u32 s56, s56, s57
    s_add_u32 s56, s56, 2097152
    v_add_u32 v96, s56, v96
    s_lshl_b32 s56, s36, 10
    s_lshl_b32 s57, s38, 7
    s_add_u32 s56, s56, s57
    s_lshl_b32 s57, s37, 2
    s_add_u32 s56, s56, s57
    v_mov_b32 v2, s56
    v_mov_b32 v3, s39
    v_lshrrev_b32 v97, 8, v0
    v_mul_u32_u24 v97, 33280, v97
    v_and_b32 v7, 255, v0
    v_lshl_add_u32 v97, v7, 4, v97
    v_add_u32 v97, 58368, v97
    s_lshl_b32 s56, s53, 13
    s_add_u32 s56, s56, 2097152
    v_lshl_add_u32 v25, v0, 4, s56
    s_mov_b32 s10, 0x11111111
    s_mov_b32 s11, 0x11111111
    s_lshr_b32 s58, s37, 2
    s_lshl_b32 s58, s58, 7
    s_lshl_b32 s57, s36, 10
    s_add_u32 s58, s58, s57
    s_add_u32 s58, s58, 65536
    v_and_b32 v100, 31, v0
    v_lshl_add_u32 v100, v100, 2, s58
    s_lshl_b32 s56, s53, 13
    s_add_u32 s56, s56, 2097152
    v_lshl_add_u32 v101, v1, 4, s56
    v_add_u32 v102, 4096, v101
    s_waitcnt vmcnt(5)
    buffer_load_dwordx4 v[34:37], v4, s[48:51], 0 offen
    s_mov_b64 exec, 1
    buffer_load_dwordx4 v[30:33], v5, s[48:51], 0 offen
    s_mov_b64 exec, -1
    v_mov_b32 v84, v18
    v_mov_b32 v85, v19
    v_mov_b32 v86, v20
    v_permlane32_swap_b32 v14, v84
    v_permlane32_swap_b32 v15, v85
    v_permlane32_swap_b32 v16, v86
    v_lshlrev_b32 v46, 16, v26
    v_lshlrev_b32 v47, 16, v28
    v_and_b32 v48, s52, v26
    v_and_b32 v49, s52, v28
    v_lshlrev_b32 v50, 16, v27
    v_lshlrev_b32 v51, 16, v29
    v_and_b32 v52, s52, v27
    v_and_b32 v53, s52, v29
    v_lshlrev_b32 v54, 16, v14
    v_and_b32 v55, s52, v14
    v_lshlrev_b32 v56, 16, v15
    v_and_b32 v57, s52, v15
    v_lshlrev_b32 v58, 16, v16
    v_and_b32 v59, s52, v16
    v_lshlrev_b32 v60, 16, v17
    v_and_b32 v61, s52, v17
    v_lshlrev_b32 v62, 16, v18
    v_and_b32 v63, s52, v18
    v_lshlrev_b32 v64, 16, v19
    v_and_b32 v65, s52, v19
    v_lshlrev_b32 v66, 16, v20
    v_and_b32 v67, s52, v20
    v_pk_mul_f32 v[76:77], v[54:55], v[52:53]
    v_pk_mul_f32 v[78:79], v[56:57], v[52:53]
    v_pk_mul_f32 v[80:81], v[58:59], v[52:53]
    v_pk_mul_f32 v[82:83], v[60:61], v[52:53]
    v_cvt_pk_bf16_f32 v76, 0, v76
    v_cvt_pk_bf16_f32 v77, 0, v77
    v_cvt_pk_bf16_f32 v78, 0, v78
    v_cvt_pk_bf16_f32 v79, 0, v79
    v_cvt_pk_bf16_f32 v80, 0, v80
    v_cvt_pk_bf16_f32 v81, 0, v81
    v_cvt_pk_bf16_f32 v82, 0, v82
    v_cvt_pk_bf16_f32 v83, 0, v83
    v_pk_mul_f32 v[84:85], v[56:57], v[50:51]
    v_pk_mul_f32 v[86:87], v[58:59], v[50:51]
    v_pk_mul_f32 v[88:89], v[60:61], v[50:51]
    v_pk_mul_f32 v[90:91], v[62:63], v[50:51]
    v_cvt_pk_bf16_f32 v84, 0, v84
    v_cvt_pk_bf16_f32 v85, 0, v85
    v_cvt_pk_bf16_f32 v86, 0, v86
    v_cvt_pk_bf16_f32 v87, 0, v87
    v_cvt_pk_bf16_f32 v88, 0, v88
    v_cvt_pk_bf16_f32 v89, 0, v89
    v_cvt_pk_bf16_f32 v90, 0, v90
    v_cvt_pk_bf16_f32 v91, 0, v91
    v_pk_add_f32 v[76:77], v[76:77], v[84:85]
    v_pk_add_f32 v[78:79], v[78:79], v[86:87]
    v_pk_add_f32 v[80:81], v[80:81], v[88:89]
    v_pk_add_f32 v[82:83], v[82:83], v[90:91]
    v_cvt_pk_bf16_f32 v76, 0, v76
    v_cvt_pk_bf16_f32 v77, 0, v77
    v_cvt_pk_bf16_f32 v78, 0, v78
    v_cvt_pk_bf16_f32 v79, 0, v79
    v_cvt_pk_bf16_f32 v80, 0, v80
    v_cvt_pk_bf16_f32 v81, 0, v81
    v_cvt_pk_bf16_f32 v82, 0, v82
    v_cvt_pk_bf16_f32 v83, 0, v83
    v_pk_mul_f32 v[84:85], v[58:59], v[48:49]
    v_pk_mul_f32 v[86:87], v[60:61], v[48:49]
    v_pk_mul_f32 v[88:89], v[62:63], v[48:49]
    v_pk_mul_f32 v[90:91], v[64:65], v[48:49]
    v_cvt_pk_bf16_f32 v84, 0, v84
    v_cvt_pk_bf16_f32 v85, 0, v85
    v_cvt_pk_bf16_f32 v86, 0, v86
    v_cvt_pk_bf16_f32 v87, 0, v87
    v_cvt_pk_bf16_f32 v88, 0, v88
    v_cvt_pk_bf16_f32 v89, 0, v89
    v_cvt_pk_bf16_f32 v90, 0, v90
    v_cvt_pk_bf16_f32 v91, 0, v91
    v_pk_add_f32 v[76:77], v[76:77], v[84:85]
    v_pk_add_f32 v[78:79], v[78:79], v[86:87]
    v_pk_add_f32 v[80:81], v[80:81], v[88:89]
    v_pk_add_f32 v[82:83], v[82:83], v[90:91]
    v_cvt_pk_bf16_f32 v76, 0, v76
    v_cvt_pk_bf16_f32 v77, 0, v77
    v_cvt_pk_bf16_f32 v78, 0, v78
    v_cvt_pk_bf16_f32 v79, 0, v79
    v_cvt_pk_bf16_f32 v80, 0, v80
    v_cvt_pk_bf16_f32 v81, 0, v81
    v_cvt_pk_bf16_f32 v82, 0, v82
    v_cvt_pk_bf16_f32 v83, 0, v83
    v_pk_mul_f32 v[84:85], v[60:61], v[46:47]
    v_pk_mul_f32 v[86:87], v[62:63], v[46:47]
    v_pk_mul_f32 v[88:89], v[64:65], v[46:47]
    v_pk_mul_f32 v[90:91], v[66:67], v[46:47]
    v_cvt_pk_bf16_f32 v84, 0, v84
    v_cvt_pk_bf16_f32 v85, 0, v85
    v_cvt_pk_bf16_f32 v86, 0, v86
    v_cvt_pk_bf16_f32 v87, 0, v87
    v_cvt_pk_bf16_f32 v88, 0, v88
    v_cvt_pk_bf16_f32 v89, 0, v89
    v_cvt_pk_bf16_f32 v90, 0, v90
    v_cvt_pk_bf16_f32 v91, 0, v91
    v_pk_add_f32 v[76:77], v[76:77], v[84:85]
    v_pk_add_f32 v[78:79], v[78:79], v[86:87]
    v_pk_add_f32 v[80:81], v[80:81], v[88:89]
    v_pk_add_f32 v[82:83], v[82:83], v[90:91]
    v_cvt_pk_bf16_f32 v76, 0, v76
    v_cvt_pk_bf16_f32 v77, 0, v77
    v_cvt_pk_bf16_f32 v78, 0, v78
    v_cvt_pk_bf16_f32 v79, 0, v79
    v_cvt_pk_bf16_f32 v80, 0, v80
    v_cvt_pk_bf16_f32 v81, 0, v81
    v_cvt_pk_bf16_f32 v82, 0, v82
    v_cvt_pk_bf16_f32 v83, 0, v83
    s_waitcnt vmcnt(3)
    buffer_load_dword v38, v40, s[64:67], 0 offen sc1
    s_mov_b64 exec, s[10:11]
    buffer_load_dword v43, v25, s[64:67], 0 offen sc1
    s_mov_b64 exec, -1
    v_lshlrev_b32 v68, 16, v21
    v_and_b32 v69, s52, v21
    v_lshlrev_b32 v70, 16, v22
    v_and_b32 v71, s52, v22
    v_lshlrev_b32 v72, 16, v23
    v_and_b32 v73, s52, v23
    v_lshlrev_b32 v74, 16, v24
    v_and_b32 v75, s52, v24
    v_pk_mul_f32 v[76:77], v[76:77], v[68:69]
    v_pk_mul_f32 v[78:79], v[78:79], v[70:71]
    v_pk_mul_f32 v[80:81], v[80:81], v[72:73]
    v_pk_mul_f32 v[82:83], v[82:83], v[74:75]
    v_cvt_pk_bf16_f32 v92, v82, v80
    v_cvt_pk_bf16_f32 v93, v78, v76
    v_cvt_pk_bf16_f32 v94, v83, v81
    v_cvt_pk_bf16_f32 v95, v79, v77
    ds_write2_b64 v98, v[92:93], v[94:95] offset0:0 offset1:16
    s_waitcnt lgkmcnt(0)
    s_barrier
    ds_read_b128 v[92:95], v99 offset:17408
    s_waitcnt lgkmcnt(0)
    buffer_store_dwordx4 v[92:95], v96, s[64:67], 0 offen
    s_waitcnt vmcnt(3)
    v_mov_b32_dpp v30, v34 wave_shr:1 row_mask:0xf bank_mask:0xf
    v_mov_b32_dpp v31, v35 wave_shr:1 row_mask:0xf bank_mask:0xf
    v_mov_b32_dpp v32, v36 wave_shr:1 row_mask:0xf bank_mask:0xf
    v_mov_b32_dpp v33, v37 wave_shr:1 row_mask:0xf bank_mask:0xf
    v_mov_b32 v46, v31
    v_mov_b32 v47, v32
    v_mov_b32 v48, v33
    v_mov_b32 v49, v34
    v_mov_b32 v50, v35
    v_mov_b32 v51, v36
    v_alignbyte_b32 v52, v31, v30, 2
    v_alignbyte_b32 v53, v32, v31, 2
    v_alignbyte_b32 v54, v33, v32, 2
    v_alignbyte_b32 v55, v34, v33, 2
    v_alignbyte_b32 v56, v35, v34, 2
    v_alignbyte_b32 v57, v36, v35, 2
    v_alignbyte_b32 v58, v32, v31, 2
    v_alignbyte_b32 v59, v33, v32, 2
    v_alignbyte_b32 v60, v34, v33, 2
    v_alignbyte_b32 v61, v35, v34, 2
    v_alignbyte_b32 v62, v36, v35, 2
    v_alignbyte_b32 v63, v37, v36, 2
    s_cmp_ge_u32 s37, 24
    s_cselect_b32 s56, 0, 1
    s_cmp_lt_u32 s37, 28
    s_cselect_b32 s57, 2, 0
    s_add_u32 s16, s56, s57
    v_lshlrev_b32 v188, 16, v44
    v_and_b32 v189, s52, v44
    v_lshlrev_b32 v190, 16, v45
    v_and_b32 v191, s52, v45
    v_mul_f32 v192, 0xbfb8aa3b, v188
    v_mul_f32 v193, 0xbfb8aa3b, v189
    v_mul_f32 v194, 0xbfb8aa3b, v190
    v_mul_f32 v195, 0xbfb8aa3b, v191
    v_exp_f32 v192, v192
    v_exp_f32 v193, v193
    v_exp_f32 v194, v194
    v_exp_f32 v195, v195
    v_add_f32 v192, 1.0, v192
    v_add_f32 v193, 1.0, v193
    v_add_f32 v194, 1.0, v194
    v_add_f32 v195, 1.0, v195
    v_rcp_f32 v192, v192
    v_rcp_f32 v193, v193
    v_rcp_f32 v194, v194
    v_rcp_f32 v195, v195
    v_mul_f32 v188, v188, v192
    v_mul_f32 v189, v189, v193
    v_mul_f32 v190, v190, v194
    v_mul_f32 v191, v191, v195
    v_cvt_pk_bf16_f32 v44, v188, v189
    v_cvt_pk_bf16_f32 v45, v190, v191
    s_sub_u32 s60, s38, 4
    s_min_u32 s61, s37, 27
    s_lshr_b32 s56, s61, 2
    s_mul_i32 s59, s36, 7
    s_add_u32 s56, s56, s59
    s_lshl_b32 s58, s56, 6
    s_and_b32 s57, s37, 3
    s_lshl_b32 s59, s57, 1
    s_and_b32 s61, s38, 1
    s_add_u32 s59, s59, s61
    s_mul_i32 s59, s59, 229376
    s_add_u32 s58, s58, s59
    v_lshrrev_b32 v144, 2, v1
    v_mul_u32_u24 v144, 3584, v144
    v_and_b32 v6, 3, v0
    v_lshl_add_u32 v144, v6, 4, v144
    v_add_u32 v144, s58, v144
    s_cmp_ge_u32 s38, 6
    s_cselect_b32 s12, s22, s20
    s_cselect_b32 s13, s23, s21
    s_lshl_b32 s58, s56, 15
    s_lshl_b32 s59, s57, 8
    s_add_u32 s58, s58, s59
    s_lshl_b32 s59, s60, 13
    s_add_u32 s58, s58, s59
    v_lshrrev_b32 v6, 4, v1
    v_lshlrev_b32 v6, 10, v6
    v_and_b32 v7, 15, v0
    v_lshl_add_u32 v6, v7, 4, v6
    v_add_u32 v145, s58, v6
    v_add_u32 v146, 4096, v145
    s_min_u32 s56, s37, 23
    s_lshr_b32 s57, s56, 2
    s_and_b32 s59, s56, 3
    s_lshl_b32 s59, s59, 7
    s_lshl_b32 s61, s60, 5
    s_add_u32 s59, s59, s61
    v_lshrrev_b32 v132, 3, v1
    v_lshl_add_u32 v132, v132, 2, s59
    s_movk_i32 s59, 6144
    v_mul_lo_u32 v132, v132, s59
    v_and_b32 v7, 7, v0
    v_lshl_add_u32 v132, v7, 4, v132
    s_lshl_b32 s57, s57, 10
    s_lshl_b32 s58, s36, 7
    s_add_u32 s57, s57, s58
    v_add_u32 v132, s57, v132
    v_lshl_add_u32 v134, v1, 1, s58
    v_subrev_u32 v135, 0x8000, v8
    v_add_u32 v6, 65536, v2
    s_mov_b32 s40, 1
    s_waitcnt vmcnt(0)
    v_cmp_ne_u32 vcc, s41, v38
    s_cbranch_vccnz L_modeslow
L_modeback:
    s_cmp_eq_u32 s40, 1
    s_cbranch_scc0 L_x1slow
L_x1back:
    s_mov_b64 exec, 1
    s_cmp_eq_u32 s40, 1
    s_cbranch_scc0 L_slow1
    buffer_store_dword v3, v6, s[64:67], 0 offen
L_back1:
    s_mov_b64 exec, -1
    s_cmp_lg_u32 s38, 4
    s_cbranch_scc1 L_nouw
    s_mov_b32 m0, 8192
L_poll1:
    buffer_load_dword v6, v100, s[64:67], 0 offen sc1
    s_waitcnt vmcnt(0)
    v_cmp_ne_u32 vcc, s39, v6
    s_sub_u32 s42, s42, 1
    s_cselect_b64 vcc, 0, vcc
    s_cselect_b32 s42, 0, s42
    s_cbranch_vccnz L_poll1
    buffer_load_dwordx4 v101, s[64:67], 0 offen offset:0 sc1 lds
    buffer_load_dwordx4 v101, s[64:67], 0 offen offset:1024 sc1 lds
    buffer_load_dwordx4 v101, s[64:67], 0 offen offset:2048 sc1 lds
    buffer_load_dwordx4 v101, s[64:67], 0 offen offset:3072 sc1 lds
    s_mov_b32 m0, 12800
    s_nop 0
    buffer_load_dwordx4 v102, s[64:67], 0 offen offset:0 sc1 lds
    buffer_load_dwordx4 v102, s[64:67], 0 offen offset:1024 sc1 lds
    buffer_load_dwordx4 v102, s[64:67], 0 offen offset:2048 sc1 lds
    buffer_load_dwordx4 v102, s[64:67], 0 offen offset:3072 sc1 lds
L_nouw:
    ds_write_b128 v97, v[52:55] offset:16
    ds_write_b128 v97, v[46:49] offset:4176
    ds_write_b128 v97, v[58:61] offset:8336
    ds_write_b128 v97, v[32:35] offset:12496
    ds_write_b128 v97, v[54:57] offset:16656
    ds_write_b128 v97, v[48:51] offset:20816
    ds_write_b128 v97, v[60:63] offset:24976
    ds_write_b128 v97, v[34:37] offset:29136
    v_mov_b32 v64, 0
    v_mov_b32 v65, 0
    v_mov_b32 v66, 0
    v_mov_b32 v67, 0
    v_mul_u32_u24 v4, 4160, v1
    v_lshrrev_b32 v5, 5, v1
    v_mul_u32_u24 v5, 4096, v5
    v_lshl_add_u32 v5, v1, 4, v5
    v_add_u32 v5, 12288, v5
    s_cmp_lg_u32 s38, 0
    s_cbranch_scc1 L_nz0
    s_mov_b64 exec, 0xffff
    ds_write_b128 v4, v[64:67] offset:58368
    s_mov_b64 exec, -1
    ds_write_b128 v5, v[64:67]
L_nz0:
    v_lshrrev_b32 v4, 3, v1
    v_and_b32 v5, 7, v0
    v_lshl_add_u32 v5, s38, 3, v5
    v_lshlrev_b32 v5, 4, v5
    v_lshl_add_u32 v108, v4, 18, v5
    s_lshl_b32 s56, s37, 13
    s_lshl_b32 s57, s36, 10
    s_add_u32 s56, s56, s57
    v_add_u32 v108, s56, v108
    v_lshl_add_u32 v109, v4, 10, v5
    s_lshl_b32 s56, s53, 13
    v_add_u32 v109, s56, v109
    s_cmp_ge_u32 s38, 4
    s_cbranch_scc1 L_helper
    v_and_b32 v4, 15, v0
    v_lshrrev_b32 v5, 4, v1
    v_and_b32 v6, 7, v0
    v_mul_u32_u24 v110, 4160, v6
    v_lshrrev_b32 v6, 3, v4
    v_add_u32 v6, v6, v5
    v_lshl_add_u32 v110, v6, 4, v110
    s_lshr_b32 s56, s38, 1
    s_and_b32 s57, s38, 1
    s_lshl_b32 s57, s57, 8
    s_mul_i32 s58, s56, 33280
    s_add_u32 s58, s58, s57
    s_add_u32 s58, s58, 58368
    v_add_u32 v110, s58, v110
    v_lshlrev_b32 v111, 4, v5
    v_lshlrev_b32 v6, 5, v4
    v_sub_u32 v111, v111, v6
    s_mul_i32 s58, s56, 4608
    s_add_u32 s58, s58, s57
    s_add_u32 s58, s58, 8672
    v_add_u32 v111, s58, v111
    v_lshl_add_u32 v6, v5, 2, v4
    v_and_b32 v6, 15, v6
    v_lshl_add_u32 v6, v5, 4, v6
    v_lshlrev_b32 v112, 4, v6
    s_lshl_b32 s56, s38, 13
    s_add_u32 s56, s56, 17408
    v_add_u32 v112, s56, v112
    s_waitcnt lgkmcnt(0)
    s_barrier
    s_setprio 3
    ds_read_b128 v[148:151], v110 offset:0
    ds_read_b128 v[152:155], v110 offset:512
    ds_read_b128 v[156:159], v110 offset:1024
    ds_read_b128 v[160:163], v110 offset:1536
    ds_read_b128 v[164:167], v110 offset:2048
    ds_read_b128 v[168:171], v110 offset:2560
    ds_read_b128 v[172:175], v110 offset:3072
    ds_read_b128 v[176:179], v110 offset:3584
    s_waitcnt lgkmcnt(0)
    s_barrier
    ds_read_b128 v[212:215], v111 offset:3584
    ds_read_b128 v[216:219], v111 offset:3072
    ds_read_b128 v[220:223], v111 offset:2560
    ds_read_b128 v[224:227], v111 offset:2048
    ds_read_b128 v[228:231], v111 offset:1536
    ds_read_b128 v[232:235], v111 offset:1024
    ds_read_b128 v[236:239], v111 offset:512
    ds_read_b128 v[240:243], v111 offset:0
    s_waitcnt lgkmcnt(7)
    v_mfma_f32_16x16x32_bf16 v[116:119], v[148:151], v[212:215], 0
    s_waitcnt lgkmcnt(6)
    v_mfma_f32_16x16x32_bf16 v[120:123], v[148:151], v[216:219], 0
    v_mfma_f32_16x16x32_bf16 v[120:123], v[152:155], v[212:215], v[120:123]
    s_waitcnt lgkmcnt(5)
    v_mfma_f32_16x16x32_bf16 v[124:127], v[148:151], v[220:223], 0
    v_mfma_f32_16x16x32_bf16 v[124:127], v[152:155], v[216:219], v[124:127]
    ds_read_b128 v[180:183], v110 offset:64
    v_mfma_f32_16x16x32_bf16 v[124:127], v[156:159], v[212:215], v[124:127]
    ds_read_b128 v[46:49], v111 offset:3648
    s_waitcnt lgkmcnt(6)
    v_mfma_f32_16x16x32_bf16 v[128:131], v[148:151], v[224:227], 0
    ds_read_b128 v[184:187], v110 offset:576
    v_mfma_f32_16x16x32_bf16 v[128:131], v[152:155], v[220:223], v[128:131]
    ds_read_b128 v[50:53], v111 offset:3136
    v_mfma_f32_16x16x32_bf16 v[128:131], v[156:159], v[216:219], v[128:131]
    ds_read_b128 v[188:191], v110 offset:1088
    v_mfma_f32_16x16x32_bf16 v[128:131], v[160:163], v[212:215], v[128:131]
    ds_read_b128 v[54:57], v111 offset:2624
    s_waitcnt lgkmcnt(9)
    v_mfma_f32_16x16x32_bf16 v[132:135], v[148:151], v[228:231], 0
    ds_read_b128 v[192:195], v110 offset:1600
    v_mfma_f32_16x16x32_bf16 v[132:135], v[152:155], v[224:227], v[132:135]
    ds_read_b128 v[58:61], v111 offset:2112
    v_mfma_f32_16x16x32_bf16 v[132:135], v[156:159], v[220:223], v[132:135]
    ds_read_b128 v[196:199], v110 offset:2112
    v_mfma_f32_16x16x32_bf16 v[132:135], v[160:163], v[216:219], v[132:135]
    ds_read_b128 v[62:65], v111 offset:1600
    v_mfma_f32_16x16x32_bf16 v[132:135], v[164:167], v[212:215], v[132:135]
    ds_read_b128 v[200:203], v110 offset:2624
    s_waitcnt lgkmcnt(13)
    v_mfma_f32_16x16x32_bf16 v[136:139], v[148:151], v[232:235], 0
    ds_read_b128 v[66:69], v111 offset:1088
    v_mfma_f32_16x16x32_bf16 v[136:139], v[152:155], v[228:231], v[136:139]
    ds_read_b128 v[204:207], v110 offset:3136
    v_mfma_f32_16x16x32_bf16 v[136:139], v[156:159], v[224:227], v[136:139]
    ds_read_b128 v[70:73], v111 offset:576
    v_mfma_f32_16x16x32_bf16 v[136:139], v[160:163], v[220:223], v[136:139]
    ds_read_b128 v[208:211], v110 offset:3648
    v_mfma_f32_16x16x32_bf16 v[136:139], v[164:167], v[216:219], v[136:139]
    ds_read_b128 v[74:77], v111 offset:64
    v_mfma_f32_16x16x32_bf16 v[136:139], v[168:171], v[212:215], v[136:139]
    s_waitcnt lgkmcnt(15)
    v_mfma_f32_16x16x32_bf16 v[140:143], v[148:151], v[236:239], 0
    v_mfma_f32_16x16x32_bf16 v[140:143], v[152:155], v[232:235], v[140:143]
    v_mfma_f32_16x16x32_bf16 v[140:143], v[156:159], v[228:231], v[140:143]
    v_mfma_f32_16x16x32_bf16 v[140:143], v[160:163], v[224:227], v[140:143]
    v_mfma_f32_16x16x32_bf16 v[140:143], v[164:167], v[220:223], v[140:143]
    v_mfma_f32_16x16x32_bf16 v[140:143], v[168:171], v[216:219], v[140:143]
    v_mfma_f32_16x16x32_bf16 v[140:143], v[172:175], v[212:215], v[140:143]
    s_waitcnt lgkmcnt(15)
    v_mfma_f32_16x16x32_bf16 v[144:147], v[148:151], v[240:243], 0
    v_mfma_f32_16x16x32_bf16 v[144:147], v[152:155], v[236:239], v[144:147]
    v_mfma_f32_16x16x32_bf16 v[144:147], v[156:159], v[232:235], v[144:147]
    v_mfma_f32_16x16x32_bf16 v[144:147], v[160:163], v[228:231], v[144:147]
    v_mfma_f32_16x16x32_bf16 v[144:147], v[164:167], v[224:227], v[144:147]
    v_mfma_f32_16x16x32_bf16 v[144:147], v[168:171], v[220:223], v[144:147]
    v_mfma_f32_16x16x32_bf16 v[144:147], v[172:175], v[216:219], v[144:147]
    v_mfma_f32_16x16x32_bf16 v[144:147], v[176:179], v[212:215], v[144:147]
    s_waitcnt lgkmcnt(0)
    v_mfma_f32_16x16x32_bf16 v[116:119], v[180:183], v[46:49], v[116:119]
    v_mfma_f32_16x16x32_bf16 v[120:123], v[180:183], v[50:53], v[120:123]
    ds_read_b128 v[148:151], v110 offset:128
    v_mfma_f32_16x16x32_bf16 v[120:123], v[184:187], v[46:49], v[120:123]
    ds_read_b128 v[212:215], v111 offset:3712
    v_mfma_f32_16x16x32_bf16 v[124:127], v[180:183], v[54:57], v[124:127]
    ds_read_b128 v[152:155], v110 offset:640
    v_mfma_f32_16x16x32_bf16 v[124:127], v[184:187], v[50:53], v[124:127]
    ds_read_b128 v[216:219], v111 offset:3200
    v_mfma_f32_16x16x32_bf16 v[124:127], v[188:191], v[46:49], v[124:127]
    ds_read_b128 v[156:159], v110 offset:1152
    v_mfma_f32_16x16x32_bf16 v[128:131], v[180:183], v[58:61], v[128:131]
    ds_read_b128 v[220:223], v111 offset:2688
    v_mfma_f32_16x16x32_bf16 v[128:131], v[184:187], v[54:57], v[128:131]
    ds_read_b128 v[160:163], v110 offset:1664
    v_mfma_f32_16x16x32_bf16 v[128:131], v[188:191], v[50:53], v[128:131]
    ds_read_b128 v[224:227], v111 offset:2176
    v_mfma_f32_16x16x32_bf16 v[128:131], v[192:195], v[46:49], v[128:131]
    ds_read_b128 v[164:167], v110 offset:2176
    v_mfma_f32_16x16x32_bf16 v[132:135], v[180:183], v[62:65], v[132:135]
    ds_read_b128 v[228:231], v111 offset:1664
    v_mfma_f32_16x16x32_bf16 v[132:135], v[184:187], v[58:61], v[132:135]
    ds_read_b128 v[168:171], v110 offset:2688
    v_mfma_f32_16x16x32_bf16 v[132:135], v[188:191], v[54:57], v[132:135]
    ds_read_b128 v[232:235], v111 offset:1152
    v_mfma_f32_16x16x32_bf16 v[132:135], v[192:195], v[50:53], v[132:135]
    ds_read_b128 v[172:175], v110 offset:3200
    v_mfma_f32_16x16x32_bf16 v[132:135], v[196:199], v[46:49], v[132:135]
    ds_read_b128 v[236:239], v111 offset:640
    v_mfma_f32_16x16x32_bf16 v[136:139], v[180:183], v[66:69], v[136:139]
    ds_read_b128 v[176:179], v110 offset:3712
    v_mfma_f32_16x16x32_bf16 v[136:139], v[184:187], v[62:65], v[136:139]
    ds_read_b128 v[240:243], v111 offset:128
    v_mfma_f32_16x16x32_bf16 v[136:139], v[188:191], v[58:61], v[136:139]
    v_mfma_f32_16x16x32_bf16 v[136:139], v[192:195], v[54:57], v[136:139]
    v_mfma_f32_16x16x32_bf16 v[136:139], v[196:199], v[50:53], v[136:139]
    v_mfma_f32_16x16x32_bf16 v[136:139], v[200:203], v[46:49], v[136:139]
    v_mfma_f32_16x16x32_bf16 v[140:143], v[180:183], v[70:73], v[140:143]
    v_mfma_f32_16x16x32_bf16 v[140:143], v[184:187], v[66:69], v[140:143]
    v_mfma_f32_16x16x32_bf16 v[140:143], v[188:191], v[62:65], v[140:143]
    v_mfma_f32_16x16x32_bf16 v[140:143], v[192:195], v[58:61], v[140:143]
    v_mfma_f32_16x16x32_bf16 v[140:143], v[196:199], v[54:57], v[140:143]
    v_mfma_f32_16x16x32_bf16 v[140:143], v[200:203], v[50:53], v[140:143]
    v_mfma_f32_16x16x32_bf16 v[140:143], v[204:207], v[46:49], v[140:143]
    v_mfma_f32_16x16x32_bf16 v[144:147], v[180:183], v[74:77], v[144:147]
    v_mfma_f32_16x16x32_bf16 v[144:147], v[184:187], v[70:73], v[144:147]
    v_mfma_f32_16x16x32_bf16 v[144:147], v[188:191], v[66:69], v[144:147]
    v_mfma_f32_16x16x32_bf16 v[144:147], v[192:195], v[62:65], v[144:147]
    v_mfma_f32_16x16x32_bf16 v[144:147], v[196:199], v[58:61], v[144:147]
    v_mfma_f32_16x16x32_bf16 v[144:147], v[200:203], v[54:57], v[144:147]
    v_mfma_f32_16x16x32_bf16 v[144:147], v[204:207], v[50:53], v[144:147]
    v_mfma_f32_16x16x32_bf16 v[144:147], v[208:211], v[46:49], v[144:147]
    s_waitcnt lgkmcnt(0)
    v_mfma_f32_16x16x32_bf16 v[116:119], v[148:151], v[212:215], v[116:119]
    v_mfma_f32_16x16x32_bf16 v[120:123], v[148:151], v[216:219], v[120:123]
    ds_read_b128 v[180:183], v110 offset:192
    v_mfma_f32_16x16x32_bf16 v[120:123], v[152:155], v[212:215], v[120:123]
    ds_read_b128 v[46:49], v111 offset:3776
    v_mfma_f32_16x16x32_bf16 v[124:127], v[148:151], v[220:223], v[124:127]
    ds_read_b128 v[184:187], v110 offset:704
    v_mfma_f32_16x16x32_bf16 v[124:127], v[152:155], v[216:219], v[124:127]
    ds_read_b128 v[50:53], v111 offset:3264
    v_mfma_f32_16x16x32_bf16 v[124:127], v[156:159], v[212:215], v[124:127]
    ds_read_b128 v[188:191], v110 offset:1216
    v_mfma_f32_16x16x32_bf16 v[128:131], v[148:151], v[224:227], v[128:131]
    ds_read_b128 v[54:57], v111 offset:2752
    v_mfma_f32_16x16x32_bf16 v[128:131], v[152:155], v[220:223], v[128:131]
    ds_read_b128 v[192:195], v110 offset:1728
    v_mfma_f32_16x16x32_bf16 v[128:131], v[156:159], v[216:219], v[128:131]
    ds_read_b128 v[58:61], v111 offset:2240
    v_mfma_f32_16x16x32_bf16 v[128:131], v[160:163], v[212:215], v[128:131]
    ds_read_b128 v[196:199], v110 offset:2240
    v_mfma_f32_16x16x32_bf16 v[132:135], v[148:151], v[228:231], v[132:135]
    ds_read_b128 v[62:65], v111 offset:1728
    v_mfma_f32_16x16x32_bf16 v[132:135], v[152:155], v[224:227], v[132:135]
    ds_read_b128 v[200:203], v110 offset:2752
    v_mfma_f32_16x16x32_bf16 v[132:135], v[156:159], v[220:223], v[132:135]
    ds_read_b128 v[66:69], v111 offset:1216
    v_mfma_f32_16x16x32_bf16 v[132:135], v[160:163], v[216:219], v[132:135]
    ds_read_b128 v[204:207], v110 offset:3264
    v_mfma_f32_16x16x32_bf16 v[132:135], v[164:167], v[212:215], v[132:135]
    ds_read_b128 v[70:73], v111 offset:704
    v_mfma_f32_16x16x32_bf16 v[136:139], v[148:151], v[232:235], v[136:139]
    ds_read_b128 v[208:211], v110 offset:3776
    v_mfma_f32_16x16x32_bf16 v[136:139], v[152:155], v[228:231], v[136:139]
    ds_read_b128 v[74:77], v111 offset:192
    v_mfma_f32_16x16x32_bf16 v[136:139], v[156:159], v[224:227], v[136:139]
    v_mfma_f32_16x16x32_bf16 v[136:139], v[160:163], v[220:223], v[136:139]
    v_mfma_f32_16x16x32_bf16 v[136:139], v[164:167], v[216:219], v[136:139]
    v_mfma_f32_16x16x32_bf16 v[136:139], v[168:171], v[212:215], v[136:139]
    v_mfma_f32_16x16x32_bf16 v[140:143], v[148:151], v[236:239], v[140:143]
    v_mfma_f32_16x16x32_bf16 v[140:143], v[152:155], v[232:235], v[140:143]
    v_mfma_f32_16x16x32_bf16 v[140:143], v[156:159], v[228:231], v[140:143]
    v_mfma_f32_16x16x32_bf16 v[140:143], v[160:163], v[224:227], v[140:143]
    v_mfma_f32_16x16x32_bf16 v[140:143], v[164:167], v[220:223], v[140:143]
    v_mfma_f32_16x16x32_bf16 v[140:143], v[168:171], v[216:219], v[140:143]
    v_mfma_f32_16x16x32_bf16 v[140:143], v[172:175], v[212:215], v[140:143]
    v_mfma_f32_16x16x32_bf16 v[144:147], v[148:151], v[240:243], v[144:147]
    v_mfma_f32_16x16x32_bf16 v[144:147], v[152:155], v[236:239], v[144:147]
    v_mfma_f32_16x16x32_bf16 v[144:147], v[156:159], v[232:235], v[144:147]
    v_mfma_f32_16x16x32_bf16 v[144:147], v[160:163], v[228:231], v[144:147]
    v_mfma_f32_16x16x32_bf16 v[144:147], v[164:167], v[224:227], v[144:147]
    v_mfma_f32_16x16x32_bf16 v[144:147], v[168:171], v[220:223], v[144:147]
    v_mfma_f32_16x16x32_bf16 v[144:147], v[172:175], v[216:219], v[144:147]
    v_mfma_f32_16x16x32_bf16 v[144:147], v[176:179], v[212:215], v[144:147]
    s_waitcnt lgkmcnt(0)
    v_mfma_f32_16x16x32_bf16 v[116:119], v[180:183], v[46:49], v[116:119]
    v_mfma_f32_16x16x32_bf16 v[120:123], v[180:183], v[50:53], v[120:123]
    v_mfma_f32_16x16x32_bf16 v[120:123], v[184:187], v[46:49], v[120:123]
    v_mfma_f32_16x16x32_bf16 v[124:127], v[180:183], v[54:57], v[124:127]
    v_mfma_f32_16x16x32_bf16 v[124:127], v[184:187], v[50:53], v[124:127]
    v_mfma_f32_16x16x32_bf16 v[124:127], v[188:191], v[46:49], v[124:127]
    v_mfma_f32_16x16x32_bf16 v[128:131], v[180:183], v[58:61], v[128:131]
    v_mfma_f32_16x16x32_bf16 v[128:131], v[184:187], v[54:57], v[128:131]
    v_mfma_f32_16x16x32_bf16 v[128:131], v[188:191], v[50:53], v[128:131]
    v_mfma_f32_16x16x32_bf16 v[128:131], v[192:195], v[46:49], v[128:131]
    ds_write_b128 v112, v[116:119] offset:0
    v_mfma_f32_16x16x32_bf16 v[132:135], v[180:183], v[62:65], v[132:135]
    v_mfma_f32_16x16x32_bf16 v[132:135], v[184:187], v[58:61], v[132:135]
    ds_write_b128 v112, v[120:123] offset:1024
    v_mfma_f32_16x16x32_bf16 v[132:135], v[188:191], v[54:57], v[132:135]
    v_mfma_f32_16x16x32_bf16 v[132:135], v[192:195], v[50:53], v[132:135]
    v_mfma_f32_16x16x32_bf16 v[132:135], v[196:199], v[46:49], v[132:135]
    ds_write_b128 v112, v[124:127] offset:2048
    v_mfma_f32_16x16x32_bf16 v[136:139], v[180:183], v[66:69], v[136:139]
    v_mfma_f32_16x16x32_bf16 v[136:139], v[184:187], v[62:65], v[136:139]
    v_mfma_f32_16x16x32_bf16 v[136:139], v[188:191], v[58:61], v[136:139]
    v_mfma_f32_16x16x32_bf16 v[136:139], v[192:195], v[54:57], v[136:139]
    ds_write_b128 v112, v[128:131] offset:3072
    v_mfma_f32_16x16x32_bf16 v[136:139], v[196:199], v[50:53], v[136:139]
    v_mfma_f32_16x16x32_bf16 v[136:139], v[200:203], v[46:49], v[136:139]
    v_mfma_f32_16x16x32_bf16 v[140:143], v[180:183], v[70:73], v[140:143]
    v_mfma_f32_16x16x32_bf16 v[140:143], v[184:187], v[66:69], v[140:143]
    v_mfma_f32_16x16x32_bf16 v[140:143], v[188:191], v[62:65], v[140:143]
    ds_write_b128 v112, v[132:135] offset:4096
    v_mfma_f32_16x16x32_bf16 v[140:143], v[192:195], v[58:61], v[140:143]
    v_mfma_f32_16x16x32_bf16 v[140:143], v[196:199], v[54:57], v[140:143]
    v_mfma_f32_16x16x32_bf16 v[140:143], v[200:203], v[50:53], v[140:143]
    v_mfma_f32_16x16x32_bf16 v[140:143], v[204:207], v[46:49], v[140:143]
    v_mfma_f32_16x16x32_bf16 v[144:147], v[180:183], v[74:77], v[144:147]
    v_mfma_f32_16x16x32_bf16 v[144:147], v[184:187], v[70:73], v[144:147]
    ds_write_b128 v112, v[136:139] offset:5120
    v_mfma_f32_16x16x32_bf16 v[144:147], v[188:191], v[66:69], v[144:147]
    v_mfma_f32_16x16x32_bf16 v[144:147], v[192:195], v[62:65], v[144:147]
    v_mfma_f32_16x16x32_bf16 v[144:147], v[196:199], v[58:61], v[144:147]
    v_mfma_f32_16x16x32_bf16 v[144:147], v[200:203], v[54:57], v[144:147]
    v_mfma_f32_16x16x32_bf16 v[144:147], v[204:207], v[50:53], v[144:147]
    v_mfma_f32_16x16x32_bf16 v[144:147], v[208:211], v[46:49], v[144:147]
    ds_write_b128 v112, v[140:143] offset:6144
    s_nop 6
    ds_write_b128 v112, v[144:147] offset:7168
    s_setprio 0
    s_branch L_s1join
L_helper:
L_h_b2a:
    s_waitcnt lgkmcnt(0)
    s_barrier
    global_load_dwordx4 v[10:13], v8, s[4:5]
    global_load_dwordx4 v[140:143], v135, s[4:5]
    global_load_ushort v231, v134, s[18:19]
    s_cmp_ge_u32 s37, 24
    s_cbranch_scc1 L_h_nog
    global_load_dwordx4 v[164:167], v132, s[28:29]
    v_add_u32 v132, s59, v132
    global_load_dwordx4 v[168:171], v132, s[28:29]
    v_add_u32 v132, s59, v132
    global_load_dwordx4 v[172:175], v132, s[28:29]
    v_add_u32 v132, s59, v132
    global_load_dwordx4 v[176:179], v132, s[28:29]
L_h_nog:
    s_cmp_lg_u32 s16, 3
    s_cbranch_scc1 L_wr1a
    s_waitcnt vmcnt(7)
L_wr1b:
    s_barrier
    s_cmp_ge_u32 s37, 28
    s_cbranch_scc1 L_h_nowa
    s_lshl_b32 s61, s60, 12
    s_add_u32 s61, s61, 124928
    s_mov_b32 m0, s61
    s_nop 0
    global_load_lds_dwordx4 v144, s[12:13]
    v_add_u32 v144, 57344, v144
    s_add_u32 s61, s61, 1024
    s_mov_b32 m0, s61
    s_nop 0
    global_load_lds_dwordx4 v144, s[12:13]
    v_add_u32 v144, 57344, v144
    s_add_u32 s61, s61, 1024
    s_mov_b32 m0, s61
    s_nop 0
    global_load_lds_dwordx4 v144, s[12:13]
    v_add_u32 v144, 57344, v144
    s_add_u32 s61, s61, 1024
    s_mov_b32 m0, s61
    s_nop 0
    global_load_lds_dwordx4 v144, s[12:13]
    s_lshl_b32 s61, s60, 11
    s_add_u32 s61, s61, 141312
    s_mov_b32 m0, s61
    s_add_u32 s61, s61, 1024
    global_load_lds_dwordx4 v145, s[24:25]
    s_mov_b32 m0, s61
    s_nop 0
    global_load_lds_dwordx4 v146, s[24:25]
L_h_nowa:
    s_lshl_b32 s56, s38, 9
    s_sub_u32 s56, 12280, s56
    v_lshlrev_b32 v4, 3, v1
    v_sub_u32 v4, s56, v4
    ds_read_b64 v[132:133], v4
    ds_read_b64 v[134:135], v4 offset:4608
    ds_read_b64 v[136:137], v4 offset:2048
    ds_read_b64 v[138:139], v4 offset:6656
    s_lshl_b32 s72, s55, 16
    s_and_b32 s73, s55, s52
    s_waitcnt lgkmcnt(0)
    v_and_b32 v116, s52, v133
    v_lshlrev_b32 v117, 16, v133
    v_and_b32 v118, s52, v132
    v_lshlrev_b32 v119, 16, v132
    v_mul_f32 v116, s72, v116
    v_mul_f32 v117, s72, v117
    v_mul_f32 v118, s72, v118
    v_mul_f32 v119, s72, v119
    v_cvt_pk_bf16_f32 v116, 0, v116
    v_cvt_pk_bf16_f32 v117, 0, v117
    v_cvt_pk_bf16_f32 v118, 0, v118
    v_cvt_pk_bf16_f32 v119, 0, v119
    v_and_b32 v120, s52, v135
    v_lshlrev_b32 v121, 16, v135
    v_and_b32 v122, s52, v134
    v_lshlrev_b32 v123, 16, v134
    v_mul_f32 v120, s73, v120
    v_mul_f32 v121, s73, v121
    v_mul_f32 v122, s73, v122
    v_mul_f32 v123, s73, v123
    v_cvt_pk_bf16_f32 v120, 0, v120
    v_cvt_pk_bf16_f32 v121, 0, v121
    v_cvt_pk_bf16_f32 v122, 0, v122
    v_cvt_pk_bf16_f32 v123, 0, v123
    v_and_b32 v124, s52, v137
    v_lshlrev_b32 v125, 16, v137
    v_and_b32 v126, s52, v136
    v_lshlrev_b32 v127, 16, v136
    v_mul_f32 v124, s72, v124
    v_mul_f32 v125, s72, v125
    v_mul_f32 v126, s72, v126
    v_mul_f32 v127, s72, v127
    v_cvt_pk_bf16_f32 v124, 0, v124
    v_cvt_pk_bf16_f32 v125, 0, v125
    v_cvt_pk_bf16_f32 v126, 0, v126
    v_cvt_pk_bf16_f32 v127, 0, v127
    v_and_b32 v128, s52, v139
    v_lshlrev_b32 v129, 16, v139
    v_and_b32 v130, s52, v138
    v_lshlrev_b32 v131, 16, v138
    v_mul_f32 v128, s73, v128
    v_mul_f32 v129, s73, v129
    v_mul_f32 v130, s73, v130
    v_mul_f32 v131, s73, v131
    v_cvt_pk_bf16_f32 v128, 0, v128
    v_cvt_pk_bf16_f32 v129, 0, v129
    v_cvt_pk_bf16_f32 v130, 0, v130
    v_cvt_pk_bf16_f32 v131, 0, v131
    s_lshl_b32 s57, s60, 11
    s_add_u32 s57, s57, 50176
    v_lshl_add_u32 v4, v1, 4, s57
    ds_write_b128 v4, v[124:127]
    ds_write_b128 v4, v[128:131] offset:1024
    s_lshl_b32 s57, s60, 10
    s_add_u32 s57, s57, 149504
    v_lshl_add_u32 v4, v1, 4, s57
    s_cmp_lg_u32 s16, 3
    s_cbranch_scc1 L_wr2a
    s_waitcnt vmcnt(11)
L_wr2b:
    ds_write_b128 v4, v[140:143]
    v_lshlrev_b32 v100, 16, v10
    v_and_b32 v101, s52, v10
    v_lshlrev_b32 v102, 16, v11
    v_and_b32 v103, s52, v11
    v_lshlrev_b32 v104, 16, v12
    v_and_b32 v105, s52, v12
    v_lshlrev_b32 v106, 16, v13
    v_and_b32 v107, s52, v13
    v_lshlrev_b32 v186, 16, v140
    v_and_b32 v187, s52, v140
    v_lshlrev_b32 v188, 16, v141
    v_and_b32 v189, s52, v141
    v_lshlrev_b32 v190, 16, v142
    v_and_b32 v191, s52, v142
    v_lshlrev_b32 v192, 16, v143
    v_and_b32 v193, s52, v143
    v_pk_add_f32 v[204:205], v[100:101], v[102:103]
    v_pk_mul_f32 v[206:207], v[100:101], v[100:101]
    v_pk_fma_f32 v[206:207], v[102:103], v[102:103], v[206:207]
    v_pk_fma_f32 v[206:207], v[104:105], v[104:105], v[206:207]
    v_pk_fma_f32 v[206:207], v[106:107], v[106:107], v[206:207]
    v_pk_add_f32 v[204:205], v[204:205], v[104:105]
    v_pk_add_f32 v[204:205], v[204:205], v[106:107]
    v_add_f32 v196, v204, v205
    v_add_f32 v198, v206, v207
    v_pk_add_f32 v[208:209], v[186:187], v[188:189]
    v_pk_mul_f32 v[210:211], v[186:187], v[186:187]
    v_pk_fma_f32 v[210:211], v[188:189], v[188:189], v[210:211]
    v_pk_fma_f32 v[210:211], v[190:191], v[190:191], v[210:211]
    v_pk_fma_f32 v[210:211], v[192:193], v[192:193], v[210:211]
    v_pk_add_f32 v[208:209], v[208:209], v[190:191]
    v_pk_add_f32 v[208:209], v[208:209], v[192:193]
    v_add_f32 v200, v208, v209
    v_add_f32 v202, v210, v211
    v_add_f32_dpp v196, v196, v196 row_ror:8 row_mask:0xf bank_mask:0xf
    v_add_f32_dpp v198, v198, v198 row_ror:8 row_mask:0xf bank_mask:0xf
    v_add_f32_dpp v200, v200, v200 row_ror:8 row_mask:0xf bank_mask:0xf
    v_add_f32_dpp v202, v202, v202 row_ror:8 row_mask:0xf bank_mask:0xf
    v_mov_b32 v204, v196
    v_mov_b32 v205, v198
    v_mov_b32 v206, v200
    v_mov_b32 v207, v202
    v_permlane16_swap_b32 v204, v196
    v_permlane16_swap_b32 v205, v198
    v_permlane16_swap_b32 v206, v200
    v_permlane16_swap_b32 v207, v202
    v_add_f32 v196, v196, v204
    v_add_f32 v198, v198, v205
    v_add_f32 v200, v200, v206
    v_add_f32 v202, v202, v207
    v_mov_b32 v204, v196
    v_mov_b32 v205, v198
    v_mov_b32 v206, v200
    v_mov_b32 v207, v202
    v_permlane32_swap_b32 v204, v196
    v_permlane32_swap_b32 v205, v198
    v_permlane32_swap_b32 v206, v200
    v_permlane32_swap_b32 v207, v202
    v_add_f32 v196, v196, v204
    v_add_f32 v198, v198, v205
    v_add_f32 v200, v200, v206
    v_add_f32 v202, v202, v207
    v_mov_b32 v197, s39
    v_mov_b32 v199, s39
    v_mov_b32 v201, s39
    v_mov_b32 v203, s39
    v_add_u32 v4, 4193792, v108
    buffer_store_dwordx4 v[196:199], v4, s[64:67], 0 offen offset:512 sc1
    buffer_store_dwordx4 v[200:203], v4, s[64:67], 0 offen sc1
    s_cmp_ge_u32 s37, 24
    s_cbranch_scc1 L_g_done
    s_cmp_lt_u32 s38, 4
    s_cbranch_scc1 L_g_done
    s_cmp_lg_u32 s16, 3
    s_cbranch_scc1 L_wr3a
    s_waitcnt vmcnt(8)
L_wr3b:
    s_mov_b32 s56, 0x05040100
    s_mov_b32 s57, 0x07060302
    v_perm_b32 v212, v168, v164, s56
    v_perm_b32 v213, v168, v164, s57
    v_perm_b32 v214, v169, v165, s56
    v_perm_b32 v215, v169, v165, s57
    v_perm_b32 v216, v170, v166, s56
    v_perm_b32 v217, v170, v166, s57
    v_perm_b32 v218, v171, v167, s56
    v_perm_b32 v219, v171, v167, s57
    v_dot2_f32_bf16 v204, v212, v44, 0
    v_dot2_f32_bf16 v205, v213, v44, 0
    v_dot2_f32_bf16 v206, v214, v44, 0
    v_dot2_f32_bf16 v207, v215, v44, 0
    v_dot2_f32_bf16 v208, v216, v44, 0
    v_dot2_f32_bf16 v209, v217, v44, 0
    v_dot2_f32_bf16 v210, v218, v44, 0
    v_dot2_f32_bf16 v211, v219, v44, 0
    v_perm_b32 v212, v176, v172, s56
    v_perm_b32 v213, v176, v172, s57
    v_perm_b32 v214, v177, v173, s56
    v_perm_b32 v215, v177, v173, s57
    v_perm_b32 v216, v178, v174, s56
    v_perm_b32 v217, v178, v174, s57
    v_perm_b32 v218, v179, v175, s56
    v_perm_b32 v219, v179, v175, s57
    v_dot2_f32_bf16 v204, v212, v45, v204
    v_dot2_f32_bf16 v205, v213, v45, v205
    v_dot2_f32_bf16 v206, v214, v45, v206
    v_dot2_f32_bf16 v207, v215, v45, v207
    v_dot2_f32_bf16 v208, v216, v45, v208
    v_dot2_f32_bf16 v209, v217, v45, v209
    v_dot2_f32_bf16 v210, v218, v45, v210
    v_dot2_f32_bf16 v211, v219, v45, v211
    v_permlane32_swap_b32 v204, v208
    v_permlane32_swap_b32 v205, v209
    v_permlane32_swap_b32 v206, v210
    v_permlane32_swap_b32 v207, v211
    v_add_f32 v204, v204, v208
    v_add_f32 v205, v205, v209
    v_add_f32 v206, v206, v210
    v_add_f32 v207, v207, v211
    s_nop 0
    v_permlane16_swap_b32 v204, v206
    v_permlane16_swap_b32 v205, v207
    v_add_f32 v204, v204, v206
    v_add_f32 v205, v205, v207
    s_nop 0
    v_add_f32_dpp v204, v204, v204 row_ror:8 row_mask:0xf bank_mask:0xf
    v_add_f32_dpp v205, v205, v205 row_ror:8 row_mask:0xf bank_mask:0xf
    v_and_b32 v4, 8, v0
    v_cmp_ne_u32 vcc, 0, v4
    s_nop 1
    v_cndmask_b32 v204, v204, v205, vcc
    v_and_b32 v4, 7, v0
    v_lshrrev_b32 v5, 3, v1
    v_lshl_add_u32 v4, v4, 3, v5
    s_sub_u32 s56, s38, 4
    s_lshl_b32 s56, s56, 8
    s_add_u32 s56, s56, 4096
    v_lshl_add_u32 v4, v4, 2, s56
    ds_write_b32 v4, v204
    v_mov_b32 v5, 3328
    v_mov_b32 v6, 1
    s_waitcnt lgkmcnt(0)
    s_mov_b64 exec, 1
    ds_add_rtn_u32 v6, v5, v6
    s_mov_b64 exec, -1
    s_waitcnt lgkmcnt(0)
    v_readfirstlane_b32 s56, v6
    s_cmp_lg_u32 s56, 3
    s_cbranch_scc1 L_g_done
    v_lshlrev_b32 v4, 2, v1
    ds_read2st64_b32 v[204:205], v4 offset0:16 offset1:17
    ds_read2st64_b32 v[206:207], v4 offset0:18 offset1:19
    s_mov_b32 s56, s37
    s_lshl_b32 s56, s56, 9
    s_lshl_b32 s57, s36, 14
    s_add_u32 s56, s56, s57
    s_add_u32 s56, s56, 262144
    v_lshl_add_u32 v4, v1, 3, s56
    s_waitcnt lgkmcnt(0)
    v_pk_add_f32 v[204:205], v[204:205], v[206:207]
    v_add_f32 v204, v204, v205
    v_mov_b32 v205, s39
    s_cmp_eq_u32 s40, 1
    s_cbranch_scc0 L_slow2
    buffer_store_dwordx2 v[204:205], v4, s[64:67], 0 offen
L_back2:
L_g_done:
L_s1join:
    v_lshrrev_b32 v4, 2, v1
    v_and_b32 v5, 3, v0
    v_lshl_add_u32 v4, v5, 2, v4
    v_and_b32 v4, 15, v4
    v_lshl_add_u32 v4, v5, 4, v4
    v_lshlrev_b32 v4, 4, v4
    s_lshl_b32 s56, s38, 10
    s_add_u32 s57, s56, 17408
    v_add_u32 v4, s57, v4
    s_lshl_b32 s57, s38, 11
    s_add_u32 s57, s57, 50176
    v_lshl_add_u32 v5, v1, 4, s57
    s_lshl_b32 s58, s53, 13
    s_add_u32 s58, s58, 2097152
    v_lshl_add_u32 v6, v0, 4, s58
    v_lshlrev_b32 v7, 4, v0
    v_add_u32 v7, 149504, v7
    v_lshrrev_b32 v9, 3, v1
    v_lshlrev_b32 v9, 5, v9
    s_waitcnt lgkmcnt(0)
    s_barrier
    ds_read_b128 v[148:151], v4 offset:0
    ds_read_b128 v[152:155], v4 offset:8192
    ds_read_b128 v[156:159], v4 offset:16384
    ds_read_b128 v[160:163], v4 offset:24576
    s_cmp_ge_u32 s38, 4
    s_cbranch_scc1 L_nokd
    ds_read_b128 v[116:119], v5
    ds_read_b128 v[120:123], v5 offset:1024
    ds_read_b128 v[10:13], v7
L_nokd:
    s_waitcnt lgkmcnt(0)
    v_pk_add_f32 v[148:149], v[148:149], v[152:153]
    v_pk_add_f32 v[150:151], v[150:151], v[154:155]
    v_pk_add_f32 v[156:157], v[156:157], v[160:161]
    v_pk_add_f32 v[158:159], v[158:159], v[162:163]
    v_cvt_pk_bf16_f32 v148, 0, v148
    v_cvt_pk_bf16_f32 v149, 0, v149
    v_cvt_pk_bf16_f32 v150, 0, v150
    v_cvt_pk_bf16_f32 v151, 0, v151
    v_cvt_pk_bf16_f32 v156, 0, v156
    v_cvt_pk_bf16_f32 v157, 0, v157
    v_cvt_pk_bf16_f32 v158, 0, v158
    v_cvt_pk_bf16_f32 v159, 0, v159
    v_pk_add_f32 v[148:149], v[148:149], v[116:117]
    v_pk_add_f32 v[150:151], v[150:151], v[118:119]
    v_pk_add_f32 v[156:157], v[156:157], v[120:121]
    v_pk_add_f32 v[158:159], v[158:159], v[122:123]
    v_cvt_pk_bf16_f32 v152, v148, v156
    v_cvt_pk_bf16_f32 v153, v149, v157
    v_cvt_pk_bf16_f32 v154, v150, v158
    v_cvt_pk_bf16_f32 v155, v151, v159
    s_cmp_eq_u32 s40, 1
    s_cbranch_scc0 L_slow3
    buffer_store_dwordx4 v[152:155], v6, s[64:67], 0 offen
L_back3:
    v_mov_b32 v139, 0
    s_min_u32 s61, s38, 5
    s_cmp_eq_u32 s38, 6
    s_cselect_b32 s61, 3, s61
    s_cmp_eq_u32 s38, 7
    s_cselect_b32 s61, 4, s61
    s_lshl_b32 s57, s61, 11
    s_lshl_b32 s58, s36, 14
    s_add_u32 s57, s57, s58
    s_add_u32 s57, s57, 262144
    v_lshl_add_u32 v56, v1, 4, s57
    v_add_u32 v57, 4194304, v109
    buffer_load_dwordx4 v[220:223], v57, s[64:67], 0 offen sc1
    v_lshlrev_b32 v100, 16, v10
    v_and_b32 v101, s52, v10
    v_lshlrev_b32 v102, 16, v11
    v_and_b32 v103, s52, v11
    v_lshlrev_b32 v104, 16, v12
    v_and_b32 v105, s52, v12
    v_lshlrev_b32 v106, 16, v13
    v_and_b32 v107, s52, v13
    v_add_u32 v5, 73728, v2
    s_lshr_b32 s58, s37, 2
    s_lshl_b32 s58, s58, 7
    s_lshl_b32 s59, s36, 10
    s_add_u32 s58, s58, s59
    s_lshl_b32 s59, s38, 4
    s_add_u32 s58, s58, s59
    s_add_u32 s58, s58, 73728
    v_and_b32 v54, 3, v0
    v_lshl_add_u32 v54, v54, 2, s58
    s_lshl_b32 s59, s38, 1
    v_subrev_u32 v55, s59, v0
    v_and_b32 v55, 15, v55
    v_lshlrev_b32 v55, 4, v55
    v_lshrrev_b32 v6, 4, v0
    v_lshl_add_u32 v55, v6, 13, v55
    s_lshl_b32 s58, s36, 18
    s_lshl_b32 s59, s37, 8
    s_add_u32 s58, s58, s59
    s_add_u32 s58, s58, 2097152
    v_add_u32 v55, s58, v55
    s_lshl_b32 s58, s38, 10
    s_add_u32 s58, s58, 58368
    s_mov_b32 m0, s58
    v_lshrrev_b32 v4, 3, v1
    v_bfe_u32 v6, v0, 2, 1
    v_lshl_add_u32 v6, s38, 1, v6
    v_lshl_add_u32 v6, v4, 1, v6
    v_and_b32 v6, 15, v6
    v_lshlrev_b32 v6, 4, v6
    v_lshl_add_u32 v68, v4, 10, v6
    v_and_b32 v6, 3, v0
    v_lshl_add_u32 v68, v6, 2, v68
    s_mov_b32 s56, s61
    s_waitcnt vmcnt(1)
    s_mov_b64 exec, 1
    s_cmp_eq_u32 s40, 1
    s_cbranch_scc0 L_slow4
    buffer_store_dword v3, v5, s[64:67], 0 offen
L_back4:
    s_mov_b64 exec, -1
    buffer_load_dwordx4 v[140:143], v56, s[64:67], 0 offen offset:0 sc1
    buffer_load_dwordx4 v[144:147], v56, s[64:67], 0 offen offset:1024 sc1
    s_waitcnt vmcnt(3)
    v_xor_b32 v221, s39, v221
    v_xor_b32 v223, s39, v223
    v_or_b32 v221, v221, v223
    v_cmp_ne_u32 vcc, 0, v221
    s_cbranch_vccnz L_pollx0
L_pollx0_back:
    v_add_f32_dpp v220, v220, v220 row_ror:8 row_mask:0xf bank_mask:0xf
    v_add_f32_dpp v222, v222, v222 row_ror:8 row_mask:0xf bank_mask:0xf
    v_mov_b32 v221, v220
    v_mov_b32 v223, v222
    s_nop 0
    v_permlane16_swap_b32 v221, v220
    v_permlane16_swap_b32 v223, v222
    v_add_f32 v220, v220, v221
    v_add_f32 v222, v222, v223
    v_mov_b32 v221, v220
    v_mov_b32 v223, v222
    s_nop 0
    v_permlane32_swap_b32 v221, v220
    v_permlane32_swap_b32 v223, v222
    v_add_f32 v220, v220, v221
    v_add_f32 v222, v222, v223
    v_mul_f32 v220, 0x3b000000, v220
    v_mul_f32 v222, 0x3b000000, v222
    v_fma_f32 v221, -v220, v220, v222
    v_max_f32 v221, 0, v221
    v_cvt_pk_bf16_f32 v64, 0, v220
    v_cvt_pk_bf16_f32 v221, 0, v221
    v_add_f32 v221, 0x3727c5ac, v221
    v_cvt_pk_bf16_f32 v221, 0, v221
    v_sqrt_f32 v221, v221
    s_nop 0
    v_cvt_pk_bf16_f32 v221, 0, v221
    v_rcp_f32 v65, v221
    v_sub_f32 v232, v100, v64
    v_sub_f32 v233, v101, v64
    v_sub_f32 v234, v102, v64
    v_sub_f32 v235, v103, v64
    v_sub_f32 v236, v104, v64
    v_sub_f32 v237, v105, v64
    v_sub_f32 v238, v106, v64
    v_sub_f32 v239, v107, v64
    v_cvt_pk_bf16_f32 v232, 0, v232
    v_cvt_pk_bf16_f32 v233, 0, v233
    v_cvt_pk_bf16_f32 v234, 0, v234
    v_cvt_pk_bf16_f32 v235, 0, v235
    v_cvt_pk_bf16_f32 v236, 0, v236
    v_cvt_pk_bf16_f32 v237, 0, v237
    v_cvt_pk_bf16_f32 v238, 0, v238
    v_cvt_pk_bf16_f32 v239, 0, v239
    v_mul_f32 v232, v232, v65
    v_mul_f32 v233, v233, v65
    v_mul_f32 v234, v234, v65
    v_mul_f32 v235, v235, v65
    v_mul_f32 v236, v236, v65
    v_mul_f32 v237, v237, v65
    v_mul_f32 v238, v238, v65
    v_mul_f32 v239, v239, v65
    v_cvt_pk_bf16_f32 v232, 0, v232
    v_cvt_pk_bf16_f32 v233, 0, v233
    v_cvt_pk_bf16_f32 v234, 0, v234
    v_cvt_pk_bf16_f32 v235, 0, v235
    v_cvt_pk_bf16_f32 v236, 0, v236
    v_cvt_pk_bf16_f32 v237, 0, v237
    v_cvt_pk_bf16_f32 v238, 0, v238
    v_cvt_pk_bf16_f32 v239, 0, v239
    s_waitcnt vmcnt(0)
    v_xor_b32 v141, s39, v141
    v_xor_b32 v143, s39, v143
    v_xor_b32 v145, s39, v145
    v_xor_b32 v147, s39, v147
    v_or3_b32 v141, v141, v143, v145
    v_or_b32 v141, v141, v147
    v_cmp_ne_u32 vcc, 0, v141
    s_cbranch_vccnz L_pollm
L_pollm_back:
    buffer_load_dword v220, v54, s[64:67], 0 offen sc1
    v_add_f32 v140, v140, v144
    v_add_f32 v142, v142, v146
    s_nop 1
    v_permlane32_swap_b32 v140, v142
    v_add_f32 v140, v140, v142
    v_cvt_pk_bf16_f32 v140, 0, v140
    v_add_f32 v141, 1.0, v140
    v_cvt_pk_bf16_f32 v141, 0, v141
    s_cmp_eq_u32 s56, 1
    s_cselect_b64 vcc, -1, 0
    s_cmp_eq_u32 s56, 4
    s_cselect_b64 vcc, -1, vcc
    v_cndmask_b32 v140, v140, v141, vcc
    v_and_b32 v4, 31, v0
    v_lshrrev_b32 v5, 5, v1
    v_lshl_add_u32 v4, v4, 1, v5
    v_lshlrev_b32 v4, 2, v4
    s_cmp_ge_u32 s38, 6
    s_cbranch_scc1 L_m67
    s_lshl_b32 s57, s56, 8
    v_add_u32 v4, s57, v4
    ds_write_b32 v4, v140 offset:0
    s_branch L_mjoin
L_m67:
    ds_bpermute_b32 v5, v4, v231
    s_waitcnt lgkmcnt(0)
    v_lshlrev_b32 v5, 16, v5
    v_mul_f32 v144, v140, v5
    s_cmp_eq_u32 s38, 7
    s_cselect_b32 s57, 0, 256
    s_cselect_b32 s58, 0, 8
    v_add_u32 v4, s57, v4
    ds_write_b32 v4, v144 offset:1536
    v_add_f32_dpp v144, v144, v144 quad_perm:[1,0,3,2] row_mask:0xf bank_mask:0xf
    s_nop 1
    v_add_f32_dpp v144, v144, v144 quad_perm:[2,3,0,1] row_mask:0xf bank_mask:0xf
    s_nop 1
    v_add_f32_dpp v144, v144, v144 row_half_mirror row_mask:0xf bank_mask:0xf
    s_nop 1
    v_add_f32_dpp v144, v144, v144 row_ror:8 row_mask:0xf bank_mask:0xf
    v_mov_b32 v146, v144
    s_nop 1
    v_permlane16_swap_b32 v146, v144
    v_add_f32 v144, v144, v146
    v_mov_b32 v146, v144
    s_nop 1
    v_permlane32_swap_b32 v146, v144
    v_add_f32 v144, v144, v146
    v_mov_b32 v145, s39
    s_lshl_b32 s56, s37, 7
    s_lshl_b32 s57, s36, 4
    s_add_u32 s56, s56, s57
    s_add_u32 s56, s56, s58
    s_add_u32 s56, s56, 131072
    v_lshl_add_u32 v139, v1, 12, s56
L_mjoin:
    s_waitcnt vmcnt(0)
    v_cmp_ne_u32 vcc, s39, v220
    s_mov_b32 s60, 0
    s_cbranch_vccnz L_p2n
    buffer_load_dwordx4 v55, s[64:67], 0 offen sc1 lds
    s_mov_b32 s60, 1
L_p2n:
    s_waitcnt lgkmcnt(0)
    s_barrier
    ds_read_b128 v[172:175], v9 offset:256
    ds_read_b128 v[176:179], v9 offset:272
    ds_read_b128 v[164:167], v9 offset:0
    ds_read_b128 v[168:171], v9 offset:16
    ds_read_b128 v[180:183], v9 offset:512
    ds_read_b128 v[184:187], v9 offset:528
    ds_read_b128 v[212:215], v9 offset:1536
    ds_read_b128 v[216:219], v9 offset:1552
    s_waitcnt lgkmcnt(4)
    v_mul_f32 v232, v232, v172
    v_mul_f32 v233, v233, v173
    v_mul_f32 v234, v234, v174
    v_mul_f32 v235, v235, v175
    v_mul_f32 v236, v236, v176
    v_mul_f32 v237, v237, v177
    v_mul_f32 v238, v238, v178
    v_mul_f32 v239, v239, v179
    v_cvt_pk_bf16_f32 v232, 0, v232
    v_cvt_pk_bf16_f32 v233, 0, v233
    v_cvt_pk_bf16_f32 v234, 0, v234
    v_cvt_pk_bf16_f32 v235, 0, v235
    v_cvt_pk_bf16_f32 v236, 0, v236
    v_cvt_pk_bf16_f32 v237, 0, v237
    v_cvt_pk_bf16_f32 v238, 0, v238
    v_cvt_pk_bf16_f32 v239, 0, v239
    v_add_f32 v232, v232, v164
    v_add_f32 v233, v233, v165
    v_add_f32 v234, v234, v166
    v_add_f32 v235, v235, v167
    v_add_f32 v236, v236, v168
    v_add_f32 v237, v237, v169
    v_add_f32 v238, v238, v170
    v_add_f32 v239, v239, v171
    v_cvt_pk_bf16_f32 v232, 0, v232
    v_cvt_pk_bf16_f32 v233, 0, v233
    v_cvt_pk_bf16_f32 v234, 0, v234
    v_cvt_pk_bf16_f32 v235, 0, v235
    v_cvt_pk_bf16_f32 v236, 0, v236
    v_cvt_pk_bf16_f32 v237, 0, v237
    v_cvt_pk_bf16_f32 v238, 0, v238
    v_cvt_pk_bf16_f32 v239, 0, v239
    s_cmp_eq_u32 s60, 1
    s_cbranch_scc1 L_p2d
L_poll2:
    buffer_load_dword v6, v54, s[64:67], 0 offen sc1
    s_waitcnt vmcnt(0)
    v_cmp_ne_u32 vcc, s39, v6
    s_sub_u32 s42, s42, 1
    s_cselect_b64 vcc, 0, vcc
    s_cselect_b32 s42, 0, s42
    s_cbranch_vccnz L_poll2
    buffer_load_dwordx4 v55, s[64:67], 0 offen sc1 lds
L_p2d:
    s_waitcnt vmcnt(0)
    s_barrier
    s_cmp_lt_u32 s38, 6
    s_cbranch_scc1 L_noxc
    s_mov_b64 exec, 0xff
    buffer_store_dwordx2 v[144:145], v139, s[64:67], 0 offen sc1
    s_mov_b64 exec, -1
L_noxc:
    ds_read2st64_b32 v[70:71], v68 offset0:228 offset1:229
    ds_read2st64_b32 v[72:73], v68 offset0:230 offset1:231
    v_add_u32 v4, 6291456, v108
    s_waitcnt lgkmcnt(0)
    v_lshlrev_b32 v74, 16, v70
    v_and_b32 v75, s52, v70
    v_lshlrev_b32 v76, 16, v71
    v_and_b32 v77, s52, v71
    v_lshlrev_b32 v78, 16, v72
    v_and_b32 v79, s52, v72
    v_lshlrev_b32 v80, 16, v73
    v_and_b32 v81, s52, v73
    v_mul_f32 v74, v74, v232
    v_mul_f32 v75, v75, v233
    v_mul_f32 v76, v76, v234
    v_mul_f32 v77, v77, v235
    v_mul_f32 v78, v78, v236
    v_mul_f32 v79, v79, v237
    v_mul_f32 v80, v80, v238
    v_mul_f32 v81, v81, v239
    v_cvt_pk_bf16_f32 v74, 0, v74
    v_cvt_pk_bf16_f32 v75, 0, v75
    v_cvt_pk_bf16_f32 v76, 0, v76
    v_cvt_pk_bf16_f32 v77, 0, v77
    v_cvt_pk_bf16_f32 v78, 0, v78
    v_cvt_pk_bf16_f32 v79, 0, v79
    v_cvt_pk_bf16_f32 v80, 0, v80
    v_cvt_pk_bf16_f32 v81, 0, v81
    v_mul_f32 v74, v74, v180
    v_mul_f32 v75, v75, v181
    v_mul_f32 v76, v76, v182
    v_mul_f32 v77, v77, v183
    v_mul_f32 v78, v78, v184
    v_mul_f32 v79, v79, v185
    v_mul_f32 v80, v80, v186
    v_mul_f32 v81, v81, v187
    v_cvt_pk_bf16_f32 v74, 0, v74
    v_cvt_pk_bf16_f32 v75, 0, v75
    v_cvt_pk_bf16_f32 v76, 0, v76
    v_cvt_pk_bf16_f32 v77, 0, v77
    v_cvt_pk_bf16_f32 v78, 0, v78
    v_cvt_pk_bf16_f32 v79, 0, v79
    v_cvt_pk_bf16_f32 v80, 0, v80
    v_cvt_pk_bf16_f32 v81, 0, v81
    v_add_f32 v74, v74, v100
    v_add_f32 v75, v75, v101
    v_add_f32 v76, v76, v102
    v_add_f32 v77, v77, v103
    v_add_f32 v78, v78, v104
    v_add_f32 v79, v79, v105
    v_add_f32 v80, v80, v106
    v_add_f32 v81, v81, v107
    v_cvt_pk_bf16_f32 v74, 0, v74
    v_cvt_pk_bf16_f32 v75, 0, v75
    v_cvt_pk_bf16_f32 v76, 0, v76
    v_cvt_pk_bf16_f32 v77, 0, v77
    v_cvt_pk_bf16_f32 v78, 0, v78
    v_cvt_pk_bf16_f32 v79, 0, v79
    v_cvt_pk_bf16_f32 v80, 0, v80
    v_cvt_pk_bf16_f32 v81, 0, v81
    v_pk_add_f32 v[82:83], v[74:75], v[76:77]
    v_pk_mul_f32 v[84:85], v[74:75], v[74:75]
    v_pk_mul_f32 v[86:87], v[74:75], v[212:213]
    v_pk_fma_f32 v[84:85], v[76:77], v[76:77], v[84:85]
    v_pk_fma_f32 v[86:87], v[76:77], v[214:215], v[86:87]
    v_pk_fma_f32 v[84:85], v[78:79], v[78:79], v[84:85]
    v_pk_fma_f32 v[86:87], v[78:79], v[216:217], v[86:87]
    v_pk_add_f32 v[82:83], v[82:83], v[78:79]
    v_pk_fma_f32 v[84:85], v[80:81], v[80:81], v[84:85]
    v_pk_fma_f32 v[86:87], v[80:81], v[218:219], v[86:87]
    v_pk_add_f32 v[82:83], v[82:83], v[80:81]
    v_add_f32 v88, v82, v83
    v_add_f32 v89, v84, v85
    v_add_f32 v90, v86, v87
    v_mov_b32 v91, s39
    v_add_f32_dpp v88, v88, v88 row_ror:8 row_mask:0xf bank_mask:0xf
    v_add_f32_dpp v89, v89, v89 row_ror:8 row_mask:0xf bank_mask:0xf
    v_add_f32_dpp v90, v90, v90 row_ror:8 row_mask:0xf bank_mask:0xf
    v_mov_b32 v82, v88
    v_mov_b32 v84, v89
    v_mov_b32 v86, v90
    v_permlane16_swap_b32 v82, v88
    v_permlane16_swap_b32 v84, v89
    v_permlane16_swap_b32 v86, v90
    v_add_f32 v88, v88, v82
    v_add_f32 v89, v89, v84
    v_add_f32 v90, v90, v86
    v_mov_b32 v82, v88
    v_mov_b32 v84, v89
    v_mov_b32 v86, v90
    v_permlane32_swap_b32 v82, v88
    v_permlane32_swap_b32 v84, v89
    v_permlane32_swap_b32 v86, v90
    v_add_f32 v88, v88, v82
    v_add_f32 v89, v89, v84
    v_add_f32 v90, v90, v86
    buffer_store_dwordx4 v[88:91], v4, s[64:67], 0 offen sc1
    ds_read_b128 v[188:191], v9 offset:768
    ds_read_b128 v[192:195], v9 offset:784
    ds_read_b128 v[196:199], v9 offset:1024
    ds_read_b128 v[200:203], v9 offset:1040
    ds_read_b128 v[204:207], v9 offset:1280
    ds_read_b128 v[208:211], v9 offset:1296
    s_lshr_b32 s58, s37, 2
    s_lshl_b32 s58, s58, 5
    s_lshl_b32 s59, s36, 2
    s_add_u32 s58, s58, s59
    s_and_b32 s59, s37, 3
    s_add_u32 s58, s58, s59
    s_mul_i32 s17, s58, 3584
    s_add_u32 s17, s17, 524288
    v_lshrrev_b32 v5, 3, v1
    s_lshl_b32 s56, s53, 7
    s_add_u32 s56, s56, 131072
    v_lshl_add_u32 v5, v5, 4, s56
    v_add_u32 v4, 6291456, v109
    v_mov_b32 v99, v4
    v_mov_b32 v48, v5
    buffer_load_dwordx4 v[50:53], v5, s[64:67], 0 offen sc1
    s_and_b32 s57, s37, 3
    s_lshl_b32 s58, s57, 9
    s_add_u32 s58, s58, 8388608
    v_and_b32 v142, 31, v0
    v_lshl_add_u32 v142, v142, 4, s58
    v_bfe_u32 v148, v0, 5, 3
    v_lshlrev_b32 v148, 2, v148
    v_and_b32 v240, 7, v0
    v_lshl_add_u32 v240, s38, 3, v240
    s_lshl_b32 s56, s37, 6
    v_add_u32 v240, s56, v240
    v_lshrrev_b32 v6, 3, v1
    s_lshl_b32 s57, s36, 8
    s_add_u32 s57, s57, 161792
    v_lshl_add_u32 v98, v6, 4, s57
    v_lshl_add_u32 v246, v240, 11, v98
    v_add_u32 v246, 8226816, v246
    v_and_b32 v4, 2, v0
    v_cmp_eq_u32 vcc, 0, v4
    s_nop 1
    v_cndmask_b32 v163, 0, -1, vcc
    v_and_b32 v4, 1, v0
    v_cmp_eq_u32 vcc, 0, v4
    s_nop 1
    v_cndmask_b32 v162, 0, -1, vcc
    s_lshl_b32 s56, s36, 11
    s_add_u32 s56, s56, 98304
    v_lshl_add_u32 v247, v1, 3, s56
    s_lshr_b32 s56, s37, 2
    s_mul_i32 s57, s36, 7
    s_add_u32 s56, s56, s57
    s_and_b32 s57, s37, 3
    v_lshrrev_b32 v5, 4, v1
    v_and_b32 v6, 7, v0
    v_lshrrev_b32 v7, 5, v1
    s_mov_b32 s10, 0x00ff00ff
    s_mov_b32 s11, 0x00ff00ff
    s_and_b32 s59, s38, 3
    v_lshl_add_u32 v7, s59, 1, v7
    v_mul_u32_u24 v146, 272, v7
    v_bfe_u32 v7, v0, 4, 1
    v_lshl_add_u32 v146, v7, 7, v146
    v_lshl_add_u32 v146, v6, 4, v146
    v_bfe_u32 v7, v0, 3, 1
    v_lshl_add_u32 v146, v7, 3, v146
    v_add_u32 v146, 17408, v146
    v_mul_u32_u24 v147, 272, v6
    v_lshl_add_u32 v147, v5, 4, v147
    s_lshr_b32 s59, s38, 2
    s_lshl_b32 s59, s59, 7
    v_add_u32 v147, s59, v147
    s_mov_b64 exec, -1
    s_and_b32 s58, s53, 0xfc
    s_lshl_b32 s58, s58, 13
    s_add_u32 s58, s58, 2097152
    s_lshl_b32 s59, s57, 3
    s_add_u32 s59, s59, s38
    s_lshl_b32 s60, s57, 13
    s_lshl_b32 s61, s38, 10
    s_add_u32 s60, s60, s61
    s_add_u32 s60, s60, s58
    v_lshl_add_u32 v143, v5, 3, v6
    v_lshl_add_u32 v143, v143, 4, s60
    s_mul_i32 s59, s59, 3584
    s_lshl_b32 s60, s56, 6
    s_add_u32 s59, s59, s60
    s_add_u32 s59, s59, 524288
    v_mul_u32_u24 v145, 114688, v6
    v_lshl_add_u32 v145, v5, 4, v145
    v_add_u32 v145, s59, v145
    s_lshr_b32 s59, s38, 2
    s_lshl_b32 s59, s59, 10
    s_and_b32 s60, s38, 3
    s_lshl_b32 s60, s60, 7
    s_add_u32 s59, s59, s60
    s_add_u32 s59, s59, s58
    v_lshlrev_b32 v144, 13, v5
    v_bfe_u32 v7, v0, 3, 1
    v_lshl_add_u32 v144, v7, 11, v144
    v_lshl_add_u32 v144, v6, 4, v144
    v_add_u32 v144, s59, v144
    v_add_u32 v151, 4096, v144
    v_and_b32 v4, 3, v0
    v_bfe_u32 v6, v0, 2, 2
    v_lshl_add_u32 v6, v5, 3, v6
    v_lshlrev_b32 v7, 6, v6
    v_lshl_add_u32 v7, v4, 3, v7
    s_lshr_b32 s56, s38, 2
    s_lshl_b32 s56, s56, 12
    s_bfe_u32 s57, s38, 0x10001
    s_lshl_b32 s57, s57, 13
    s_add_u32 s56, s56, s57
    s_and_b32 s57, s38, 1
    s_lshl_b32 s57, s57, 5
    s_add_u32 s56, s56, s57
    s_add_u32 s56, s56, 124928
    v_add_u32 v7, s56, v7
    ds_read_b64_tr_b16 v[130:131], v7 offset:0
    ds_read_b64_tr_b16 v[132:133], v7 offset:256
    ds_read_b64_tr_b16 v[134:135], v7 offset:2048
    ds_read_b64_tr_b16 v[136:137], v7 offset:2304
    v_lshlrev_b32 v7, 8, v6
    v_lshl_add_u32 v7, v4, 3, v7
    s_lshl_b32 s56, s38, 5
    s_add_u32 s56, s56, 141312
    v_add_u32 v7, s56, v7
    ds_read_b64_tr_b16 v[138:139], v7
    ds_read_b64_tr_b16 v[140:141], v7 offset:1024
    v_and_b32 v4, 7, v0
    v_lshrrev_b32 v5, 5, v1
    v_bfe_u32 v6, v0, 4, 1
    v_lshl_add_u32 v5, v5, 1, v6
    v_lshl_add_u32 v5, s38, 2, v5
    v_lshlrev_b32 v5, 1, v5
    v_lshl_add_u32 v152, v4, 6, v5
    v_lshrrev_b32 v6, 4, v1
    v_lshlrev_b32 v6, 4, v6
    v_lshl_add_u32 v153, v4, 6, v6
    buffer_load_dwordx4 v[92:95], v99, s[64:67], 0 offen sc1
    s_waitcnt vmcnt(1)
    v_xor_b32 v6, s39, v51
    v_xor_b32 v7, s39, v53
    v_or_b32 v6, v6, v7
    v_cmp_ne_u32 vcc, 0, v6
    s_cbranch_vccnz L_pollc
L_pollc_back:
    v_add_f32_dpp v50, v50, v50 row_ror:8 row_mask:0xf bank_mask:0xf
    v_add_f32_dpp v52, v52, v52 row_ror:8 row_mask:0xf bank_mask:0xf
    v_mov_b32 v82, v50
    v_mov_b32 v84, v52
    s_nop 0
    v_permlane16_swap_b32 v82, v50
    v_permlane16_swap_b32 v84, v52
    v_add_f32 v50, v50, v82
    v_add_f32 v52, v52, v84
    v_mov_b32 v82, v50
    v_mov_b32 v84, v52
    s_nop 0
    v_permlane32_swap_b32 v82, v50
    v_permlane32_swap_b32 v84, v52
    v_add_f32 v50, v50, v82
    v_add_f32 v52, v52, v84
    v_and_b32 v5, 7, v0
    v_lshl_add_u32 v5, s38, 3, v5
    s_lshl_b32 s56, s37, 6
    s_sub_u32 s56, 2047, s56
    v_sub_u32 v46, s56, v5
    v_lshlrev_b32 v47, 2, v5
    v_mov_b32 v6, 0
    ds_write_b32 v47, v6 offset:3584
    s_waitcnt vmcnt(0)
    v_cmp_ne_u32 vcc, s39, v95
    s_cbranch_vccnz L_poll3
L_poll3_back:
    v_add_f32_dpp v92, v92, v92 row_ror:8 row_mask:0xf bank_mask:0xf
    v_add_f32_dpp v93, v93, v93 row_ror:8 row_mask:0xf bank_mask:0xf
    v_add_f32_dpp v94, v94, v94 row_ror:8 row_mask:0xf bank_mask:0xf
    v_mov_b32 v82, v92
    v_mov_b32 v84, v93
    v_mov_b32 v86, v94
    v_permlane16_swap_b32 v82, v92
    v_permlane16_swap_b32 v84, v93
    v_permlane16_swap_b32 v86, v94
    v_add_f32 v92, v92, v82
    v_add_f32 v93, v93, v84
    v_add_f32 v94, v94, v86
    v_mov_b32 v82, v92
    v_mov_b32 v84, v93
    v_mov_b32 v86, v94
    v_permlane32_swap_b32 v82, v92
    v_permlane32_swap_b32 v84, v93
    v_permlane32_swap_b32 v86, v94
    v_add_f32 v92, v92, v82
    v_add_f32 v93, v93, v84
    v_add_f32 v94, v94, v86
    v_mul_f32 v92, 0x3b000000, v92
    v_mul_f32 v93, 0x3b000000, v93
    v_fma_f32 v82, -v92, v92, v93
    v_max_f32 v82, 0, v82
    v_cvt_pk_bf16_f32 v64, 0, v92
    v_cvt_pk_bf16_f32 v82, 0, v82
    v_add_f32 v82, 0x3727c5ac, v82
    v_cvt_pk_bf16_f32 v82, 0, v82
    v_sqrt_f32 v82, v82
    s_nop 0
    v_cvt_pk_bf16_f32 v82, 0, v82
    v_rcp_f32 v65, v82
    v_fma_f32 v96, -v64, v50, v94
    v_fma_f32 v96, v96, v65, v52
    v_cvt_pk_bf16_f32 v96, 0, v96
    v_ashrrev_i32 v4, 31, v96
    v_or_b32 v4, 0x80000000, v4
    v_and_b32 v4, s52, v4
    v_xor_b32 v96, v96, v4
    v_or_b32 v96, v96, v46
    ds_write_b32 v47, v96 offset:2048
    s_waitcnt lgkmcnt(0)
    s_barrier
    ds_read_b128 v[92:95], v9 offset:2048
    ds_read_b128 v[82:85], v9 offset:2064
    v_sub_f32 v56, v74, v64
    v_sub_f32 v57, v75, v64
    v_sub_f32 v58, v76, v64
    v_sub_f32 v59, v77, v64
    v_sub_f32 v60, v78, v64
    v_sub_f32 v61, v79, v64
    v_sub_f32 v62, v80, v64
    v_sub_f32 v63, v81, v64
    v_cvt_pk_bf16_f32 v56, 0, v56
    v_cvt_pk_bf16_f32 v57, 0, v57
    v_cvt_pk_bf16_f32 v58, 0, v58
    v_cvt_pk_bf16_f32 v59, 0, v59
    v_cvt_pk_bf16_f32 v60, 0, v60
    v_cvt_pk_bf16_f32 v61, 0, v61
    v_cvt_pk_bf16_f32 v62, 0, v62
    v_cvt_pk_bf16_f32 v63, 0, v63
    s_waitcnt lgkmcnt(0)
    v_mov_b32 v97, 0
    v_cmp_gt_u32 s[44:45], v92, v96
    v_cmp_gt_u32 s[46:47], v93, v96
    v_cmp_gt_u32 s[48:49], v94, v96
    v_cmp_gt_u32 s[50:51], v95, v96
    v_addc_co_u32 v97, s[44:45], 0, v97, s[44:45]
    v_addc_co_u32 v97, s[46:47], 0, v97, s[46:47]
    v_addc_co_u32 v97, s[48:49], 0, v97, s[48:49]
    v_addc_co_u32 v97, s[50:51], 0, v97, s[50:51]
    v_cmp_gt_u32 s[44:45], v82, v96
    v_cmp_gt_u32 s[46:47], v83, v96
    v_cmp_gt_u32 s[48:49], v84, v96
    v_cmp_gt_u32 s[50:51], v85, v96
    v_addc_co_u32 v97, s[44:45], 0, v97, s[44:45]
    v_addc_co_u32 v97, s[46:47], 0, v97, s[46:47]
    v_addc_co_u32 v97, s[48:49], 0, v97, s[48:49]
    v_addc_co_u32 v97, s[50:51], 0, v97, s[50:51]
    s_nop 1
    v_add_u32_dpp v97, v97, v97 row_ror:8 row_mask:0xf bank_mask:0xf
    v_mov_b32 v4, v97
    s_nop 1
    v_permlane16_swap_b32 v4, v97
    v_add_u32 v97, v97, v4
    v_mov_b32 v4, v97
    s_nop 1
    v_permlane32_swap_b32 v4, v97
    v_add_u32 v97, v97, v4
    s_lshl_b32 s56, s53, 6
    s_add_u32 s56, s56, 98304
    v_lshl_add_u32 v4, v97, 3, s56
    v_mov_b32 v92, v96
    v_mov_b32 v93, s39
    v_cmp_gt_u32 s[62:63], 8, v97
    s_and_b64 exec, s[62:63], 0xff
    s_cbranch_execz L_nokey
    s_cmp_eq_u32 s40, 1
    s_cbranch_scc0 L_slow5
    buffer_store_dwordx2 v[92:93], v4, s[64:67], 0 offen
L_back5:
L_nokey:
    s_mov_b64 exec, -1
    v_mul_f32 v56, v56, v65
    v_mul_f32 v57, v57, v65
    v_mul_f32 v58, v58, v65
    v_mul_f32 v59, v59, v65
    v_mul_f32 v60, v60, v65
    v_mul_f32 v61, v61, v65
    v_mul_f32 v62, v62, v65
    v_mul_f32 v63, v63, v65
    v_cvt_pk_bf16_f32 v56, 0, v56
    v_cvt_pk_bf16_f32 v57, 0, v57
    v_cvt_pk_bf16_f32 v58, 0, v58
    v_cvt_pk_bf16_f32 v59, 0, v59
    v_cvt_pk_bf16_f32 v60, 0, v60
    v_cvt_pk_bf16_f32 v61, 0, v61
    v_cvt_pk_bf16_f32 v62, 0, v62
    v_cvt_pk_bf16_f32 v63, 0, v63
    v_mul_f32 v56, v56, v196
    v_mul_f32 v57, v57, v197
    v_mul_f32 v58, v58, v198
    v_mul_f32 v59, v59, v199
    v_mul_f32 v60, v60, v200
    v_mul_f32 v61, v61, v201
    v_mul_f32 v62, v62, v202
    v_mul_f32 v63, v63, v203
    v_cvt_pk_bf16_f32 v56, 0, v56
    v_cvt_pk_bf16_f32 v57, 0, v57
    v_cvt_pk_bf16_f32 v58, 0, v58
    v_cvt_pk_bf16_f32 v59, 0, v59
    v_cvt_pk_bf16_f32 v60, 0, v60
    v_cvt_pk_bf16_f32 v61, 0, v61
    v_cvt_pk_bf16_f32 v62, 0, v62
    v_cvt_pk_bf16_f32 v63, 0, v63
    v_add_f32 v56, v56, v188
    v_add_f32 v57, v57, v189
    v_add_f32 v58, v58, v190
    v_add_f32 v59, v59, v191
    v_add_f32 v60, v60, v192
    v_add_f32 v61, v61, v193
    v_add_f32 v62, v62, v194
    v_add_f32 v63, v63, v195
    v_cvt_pk_bf16_f32 v110, v56, v57
    v_mov_b32 v111, s39
    v_cvt_pk_bf16_f32 v112, v58, v59
    v_mov_b32 v113, s39
    v_cvt_pk_bf16_f32 v114, v60, v61
    v_mov_b32 v115, s39
    v_cvt_pk_bf16_f32 v116, v62, v63
    v_mov_b32 v117, s39
    v_cvt_pk_bf16_f32 v118, v74, v75
    v_mov_b32 v119, s39
    v_cvt_pk_bf16_f32 v120, v76, v77
    v_mov_b32 v121, s39
    v_cvt_pk_bf16_f32 v122, v78, v79
    v_mov_b32 v123, s39
    v_cvt_pk_bf16_f32 v124, v80, v81
    v_mov_b32 v125, s39
    s_mov_b64 exec, s[62:63]
    s_cbranch_execz L_noh2c
    buffer_store_dwordx4 v[110:113], v246, s[64:67], 0 offen sc1
    buffer_store_dwordx4 v[114:117], v246, s[64:67], 0 offen offset:128 sc1
L_noh2c:
    s_mov_b64 exec, -1
    s_cmp_lg_u32 s38, 0
    s_cbranch_scc1 L_kskip
L_pollk:
    buffer_load_dwordx2 v[154:155], v247, s[64:67], 0 offen offset:0 sc1
    buffer_load_dwordx2 v[156:157], v247, s[64:67], 0 offen offset:512 sc1
    buffer_load_dwordx2 v[158:159], v247, s[64:67], 0 offen offset:1024 sc1
    buffer_load_dwordx2 v[160:161], v247, s[64:67], 0 offen offset:1536 sc1
    s_waitcnt vmcnt(0)
    v_xor_b32 v5, s39, v155
    v_xor_b32 v6, s39, v157
    v_xor_b32 v7, s39, v159
    v_or3_b32 v5, v5, v6, v7
    v_xor_b32 v6, s39, v161
    v_or_b32 v5, v5, v6
    v_cmp_ne_u32 vcc, 0, v5
    s_sub_u32 s42, s42, 1
    s_cselect_b64 vcc, 0, vcc
    s_cselect_b32 s42, 0, s42
    s_cbranch_vccnz L_pollk
    v_max_u32_dpp v154, v156, v154 row_half_mirror row_mask:0xf bank_mask:0xf
    v_max_u32_dpp v158, v160, v158 row_half_mirror row_mask:0xf bank_mask:0xf
    s_nop 0
    v_max_u32_dpp v155, v154, v154 row_shl:4 row_mask:0xf bank_mask:0x5
    v_max_u32_dpp v157, v158, v158 row_shl:4 row_mask:0xf bank_mask:0x5
    s_nop 0
    v_min_u32_dpp v155, v154, v154 row_shr:4 row_mask:0xf bank_mask:0xa
    v_min_u32_dpp v157, v158, v158 row_shr:4 row_mask:0xf bank_mask:0xa
    s_nop 0
    v_mov_b32_dpp v154, v155 quad_perm:[2,3,0,1] row_mask:0xf bank_mask:0xf
    v_mov_b32_dpp v158, v157 quad_perm:[2,3,0,1] row_mask:0xf bank_mask:0xf
    v_med3_u32 v155, v155, v154, v163
    v_med3_u32 v157, v157, v158, v163
    s_nop 0
    v_mov_b32_dpp v154, v155 quad_perm:[1,0,3,2] row_mask:0xf bank_mask:0xf
    v_mov_b32_dpp v158, v157 quad_perm:[1,0,3,2] row_mask:0xf bank_mask:0xf
    v_med3_u32 v154, v155, v154, v162
    v_med3_u32 v158, v157, v158, v162
    s_nop 1
    v_max_u32_dpp v154, v158, v154 row_half_mirror row_mask:0xf bank_mask:0xf
    s_nop 1
    v_max_u32_dpp v155, v154, v154 row_shl:4 row_mask:0xf bank_mask:0x5
    s_nop 1
    v_min_u32_dpp v155, v154, v154 row_shr:4 row_mask:0xf bank_mask:0xa
    s_nop 1
    v_mov_b32_dpp v154, v155 quad_perm:[2,3,0,1] row_mask:0xf bank_mask:0xf
    v_med3_u32 v155, v155, v154, v163
    s_nop 1
    v_mov_b32_dpp v154, v155 quad_perm:[1,0,3,2] row_mask:0xf bank_mask:0xf
    v_med3_u32 v154, v155, v154, v162
    s_nop 1
    v_max_u32_dpp v154, v154, v154 row_mirror row_mask:0xf bank_mask:0xf
    s_nop 1
    v_max_u32_dpp v155, v154, v154 row_shl:4 row_mask:0xf bank_mask:0x5
    s_nop 1
    v_min_u32_dpp v155, v154, v154 row_shr:4 row_mask:0xf bank_mask:0xa
    s_nop 1
    v_mov_b32_dpp v154, v155 quad_perm:[2,3,0,1] row_mask:0xf bank_mask:0xf
    v_med3_u32 v155, v155, v154, v163
    s_nop 1
    v_mov_b32_dpp v154, v155 quad_perm:[1,0,3,2] row_mask:0xf bank_mask:0xf
    v_med3_u32 v154, v155, v154, v162
    v_mov_b32 v157, v154
    s_nop 1
    v_permlane16_swap_b32 v157, v154
    s_nop 1
    v_max_u32_dpp v154, v154, v157 row_half_mirror row_mask:0xf bank_mask:0xf
    s_nop 1
    v_max_u32_dpp v155, v154, v154 row_shl:4 row_mask:0xf bank_mask:0x5
    s_nop 1
    v_min_u32_dpp v155, v154, v154 row_shr:4 row_mask:0xf bank_mask:0xa
    s_nop 1
    v_mov_b32_dpp v154, v155 quad_perm:[2,3,0,1] row_mask:0xf bank_mask:0xf
    v_med3_u32 v155, v155, v154, v163
    s_nop 1
    v_mov_b32_dpp v154, v155 quad_perm:[1,0,3,2] row_mask:0xf bank_mask:0xf
    v_med3_u32 v154, v155, v154, v162
    v_mov_b32 v157, v154
    s_nop 1
    v_permlane32_swap_b32 v157, v154
    s_nop 1
    v_max_u32_dpp v154, v154, v157 row_half_mirror row_mask:0xf bank_mask:0xf
    s_nop 1
    v_max_u32_dpp v155, v154, v154 row_shl:4 row_mask:0xf bank_mask:0x5
    s_nop 1
    v_min_u32_dpp v155, v154, v154 row_shr:4 row_mask:0xf bank_mask:0xa
    s_nop 1
    v_mov_b32_dpp v154, v155 quad_perm:[2,3,0,1] row_mask:0xf bank_mask:0xf
    v_med3_u32 v155, v155, v154, v163
    s_nop 1
    v_mov_b32_dpp v154, v155 quad_perm:[1,0,3,2] row_mask:0xf bank_mask:0xf
    v_med3_u32 v154, v155, v154, v162
    v_and_b32 v156, 0x7ff, v154
    v_sub_u32 v156, 2047, v156
    v_lshlrev_b32 v6, 2, v1
    ds_write_b32 v6, v156 offset:4096
    s_lshl_b32 s56, s37, 6
    v_subrev_u32 v5, s56, v156
    v_add_u32 v7, 1, v1
    v_cmp_gt_u32 vcc, 64, v5
    v_lshlrev_b32 v5, 2, v5
    s_and_b64 exec, vcc, 0xff
    ds_write_b32 v5, v7 offset:3584
    s_mov_b64 exec, -1
    s_waitcnt lgkmcnt(0)
    s_branch L_kjoin
L_kskip:
    v_lshlrev_b32 v56, 16, v110
    v_and_b32 v57, s52, v110
    v_lshlrev_b32 v58, 16, v112
    v_and_b32 v59, s52, v112
    v_lshlrev_b32 v60, 16, v114
    v_and_b32 v61, s52, v114
    v_lshlrev_b32 v62, 16, v116
    v_and_b32 v63, s52, v116
    v_mul_f32 v56, v56, v204
    v_mul_f32 v57, v57, v205
    v_mul_f32 v58, v58, v206
    v_mul_f32 v59, v59, v207
    v_mul_f32 v60, v60, v208
    v_mul_f32 v61, v61, v209
    v_mul_f32 v62, v62, v210
    v_mul_f32 v63, v63, v211
    v_cvt_pk_bf16_f32 v56, 0, v56
    v_cvt_pk_bf16_f32 v57, 0, v57
    v_cvt_pk_bf16_f32 v58, 0, v58
    v_cvt_pk_bf16_f32 v59, 0, v59
    v_cvt_pk_bf16_f32 v60, 0, v60
    v_cvt_pk_bf16_f32 v61, 0, v61
    v_cvt_pk_bf16_f32 v62, 0, v62
    v_cvt_pk_bf16_f32 v63, 0, v63
    v_add_f32 v56, v56, v74
    v_add_f32 v57, v57, v75
    v_add_f32 v58, v58, v76
    v_add_f32 v59, v59, v77
    v_add_f32 v60, v60, v78
    v_add_f32 v61, v61, v79
    v_add_f32 v62, v62, v80
    v_add_f32 v63, v63, v81
    v_cvt_pk_bf16_f32 v126, v56, v57
    v_cvt_pk_bf16_f32 v127, v58, v59
    v_cvt_pk_bf16_f32 v128, v60, v61
    v_cvt_pk_bf16_f32 v129, v62, v63
L_kjoin:
    s_barrier
    ds_read_b32 v149, v148 offset:4096
    ds_read_b32 v150, v47 offset:3584
    s_cmp_ge_u32 s37, 28
    s_cbranch_scc1 L_nog1
    s_cmp_ge_u32 s38, 4
    s_cbranch_scc1 L_nog1
    s_waitcnt lgkmcnt(1)
    v_lshl_add_u32 v142, v149, 11, v142
    buffer_load_dwordx4 v[166:169], v142, s[64:67], 0 offen sc1
L_nog1:
    s_waitcnt lgkmcnt(0)
    v_cmp_ne_u32 s[62:63], 0, v150
    v_lshl_add_u32 v4, v150, 11, v98
    v_add_u32 v4, 16384, v4
    s_mov_b64 exec, s[62:63]
    s_cbranch_execz L_noh2
    buffer_store_dwordx4 v[118:121], v4, s[64:67], 0 offen sc1
    buffer_store_dwordx4 v[122:125], v4, s[64:67], 0 offen offset:128 sc1
L_noh2:
    s_mov_b64 exec, -1
    s_cmp_lg_u32 s38, 0
    s_cbranch_scc1 L_noc
    v_lshlrev_b32 v56, 16, v110
    v_and_b32 v57, s52, v110
    v_lshlrev_b32 v58, 16, v112
    v_and_b32 v59, s52, v112
    v_lshlrev_b32 v60, 16, v114
    v_and_b32 v61, s52, v114
    v_lshlrev_b32 v62, 16, v116
    v_and_b32 v63, s52, v116
    v_mul_f32 v56, v56, v204
    v_mul_f32 v57, v57, v205
    v_mul_f32 v58, v58, v206
    v_mul_f32 v59, v59, v207
    v_mul_f32 v60, v60, v208
    v_mul_f32 v61, v61, v209
    v_mul_f32 v62, v62, v210
    v_mul_f32 v63, v63, v211
    v_cvt_pk_bf16_f32 v56, 0, v56
    v_cvt_pk_bf16_f32 v57, 0, v57
    v_cvt_pk_bf16_f32 v58, 0, v58
    v_cvt_pk_bf16_f32 v59, 0, v59
    v_cvt_pk_bf16_f32 v60, 0, v60
    v_cvt_pk_bf16_f32 v61, 0, v61
    v_cvt_pk_bf16_f32 v62, 0, v62
    v_cvt_pk_bf16_f32 v63, 0, v63
    v_add_f32 v56, v56, v74
    v_add_f32 v57, v57, v75
    v_add_f32 v58, v58, v76
    v_add_f32 v59, v59, v77
    v_add_f32 v60, v60, v78
    v_add_f32 v61, v61, v79
    v_add_f32 v62, v62, v80
    v_add_f32 v63, v63, v81
    v_cvt_pk_bf16_f32 v126, v56, v57
    v_cvt_pk_bf16_f32 v127, v58, v59
    v_cvt_pk_bf16_f32 v128, v60, v61
    v_cvt_pk_bf16_f32 v129, v62, v63
L_noc:
    s_andn2_b64 exec, exec, s[62:63]
    s_cbranch_execz L_noout3
    buffer_store_dwordx4 v[126:129], v8, s[68:71], 0 offen
L_noout2:
    s_mov_b64 exec, -1
    s_cmp_ge_u32 s37, 28
    s_cbranch_scc1 L_tail
    s_mov_b64 s[48:49], -1
    s_mov_b64 s[50:51], -1
    s_mov_b32 s58, 0x03020105
    s_mov_b32 s59, 0x03020106
    s_mov_b32 s60, 0x03020107
    s_mov_b32 s56, 0x0004000c
    s_mov_b32 s57, 0x0402010c
    s_mov_b64 s[44:45], -1
    s_mov_b64 s[46:47], -1
    s_cmp_ge_u32 s38, 4
    s_cbranch_scc1 L_gskip
    s_waitcnt vmcnt(1)
    v_xor_b32 v167, s39, v167
    v_xor_b32 v169, s39, v169
    v_or_b32 v167, v167, v169
    v_cmp_ne_u32 vcc, 0, v167
    s_cbranch_vccnz L_pollg
L_pollg_back:
    ds_write2_b32 v146, v166, v168 offset0:0 offset1:1
L_gskip:
    s_waitcnt lgkmcnt(0)
    s_barrier
    ds_read_b128 v[166:169], v147 offset:17408
    ds_read_b128 v[174:177], v147 offset:17472
    s_waitcnt lgkmcnt(1)
    v_mfma_f32_16x16x32_bf16 v[182:185], v[130:133], v[166:169], 0
    s_waitcnt lgkmcnt(0)
    v_mfma_f32_16x16x32_bf16 v[182:185], v[134:137], v[174:177], v[182:185]
    v_mov_b32 v189, s39
    s_nop 6
    v_mov_b32 v186, v184
    v_mov_b32 v187, v185
    v_mov_b32 v185, s39
    s_mov_b64 exec, s[10:11]
    s_cmp_eq_u32 s40, 1
    s_cbranch_scc0 L_slow6
    buffer_store_dwordx4 v[182:185], v143, s[64:67], 0 offen
    buffer_store_dwordx4 v[186:189], v143, s[64:67], 0 offen offset:512
L_back6:
L_pollx:
    s_mov_b64 exec, s[44:45]
    s_cbranch_execz L_pollx_s0
    buffer_load_dwordx4 v[166:169], v144, s[64:67], 0 offen offset:0 sc1
L_pollx_s0:
    s_mov_b64 exec, s[46:47]
    s_cbranch_execz L_pollx_s1
    buffer_load_dwordx4 v[170:173], v144, s[64:67], 0 offen offset:512 sc1
L_pollx_s1:
    s_mov_b64 exec, s[48:49]
    s_cbranch_execz L_pollx_s2
    buffer_load_dwordx4 v[174:177], v151, s[64:67], 0 offen offset:0 sc1
L_pollx_s2:
    s_mov_b64 exec, s[50:51]
    s_cbranch_execz L_pollx_s3
    buffer_load_dwordx4 v[178:181], v151, s[64:67], 0 offen offset:512 sc1
L_pollx_s3:
    s_mov_b64 exec, -1
    s_waitcnt vmcnt(0)
    v_cmp_ne_u32 s[44:45], s39, v169
    v_cmp_ne_u32 s[46:47], s39, v173
    v_cmp_ne_u32 s[48:49], s39, v177
    v_cmp_ne_u32 s[50:51], s39, v181
    s_or_b64 vcc, s[44:45], s[46:47]
    s_or_b64 vcc, vcc, s[48:49]
    s_or_b64 vcc, vcc, s[50:51]
    s_sub_u32 s42, s42, 1
    s_cselect_b64 vcc, 0, vcc
    s_cselect_b32 s42, 0, s42
    s_cbranch_vccnz L_pollx
    v_pk_add_f32 v[166:167], v[166:167], v[174:175]
    v_pk_add_f32 v[168:169], v[170:171], v[178:179]
    s_nop 1
    v_permlane32_swap_b32 v166, v168
    v_permlane32_swap_b32 v167, v169
    v_add_f32 v166, v166, v168
    v_add_f32 v167, v167, v169
    s_nop 1
    v_permlane16_swap_b32 v166, v167
    v_add_f32 v166, v166, v167
    v_cvt_pk_bf16_f32 v166, 0, v166
    v_mul_f32 v168, 0xbfb8aa3b, v166
    v_exp_f32 v168, v168
    v_mov_b32_dpp v167, v166 row_ror:8 row_mask:0xf bank_mask:0xf
    v_add_f32 v168, 1.0, v168
    v_rcp_f32 v168, v168
    s_nop 0
    v_mul_f32 v166, v166, v168
    v_cvt_pk_bf16_f32 v166, 0, v166
    v_mul_f32 v166, v166, v167
    v_cvt_pk_bf16_f32 v166, v166, v166
    s_mov_b64 exec, s[10:11]
    ds_write_b16 v152, v166 offset:25600
    s_mov_b64 exec, -1
    s_waitcnt lgkmcnt(0)
    s_barrier
    ds_read_b128 v[166:169], v153 offset:25600
    s_waitcnt lgkmcnt(0)
    v_mfma_f32_16x16x32_bf16 v[182:185], v[138:141], v[166:169], 0
    s_nop 7
    v_perm_b32 v182, v185, v182, s58
    v_perm_b32 v183, v185, v183, s59
    v_perm_b32 v184, v185, v184, s60
    v_mov_b32 v185, s39
    s_mov_b64 exec, s[10:11]
    buffer_store_dwordx4 v[182:185], v145, s[64:67], 0 offen sc1
    s_mov_b64 exec, -1
    s_cmp_lg_u32 s53, 0
    s_cbranch_scc1 L_noep
    s_cmp_lg_u32 s38, 2
    s_cbranch_scc1 L_noep
    s_add_u32 s56, s54, 1
    v_mov_b32 v6, 0
    v_mov_b32 v7, s56
    s_mov_b64 exec, 1
    buffer_store_dword v7, v6, s[64:67], 0 offen sc1
    s_mov_b64 exec, -1
L_noep:
L_tail:
    s_cmp_lg_u32 s37, 28
    s_cbranch_scc1 L_red
    v_lshlrev_b32 v5, 4, v1
    global_load_dwordx4 v[130:133], v5, s[18:19]
    s_lshl_b32 s59, s38, 2
    v_mov_b32 v4, s59
    ds_read_b32 v4, v4 offset:4096
    v_lshrrev_b32 v6, 3, v1
    v_and_b32 v7, 7, v0
    v_lshlrev_b32 v7, 4, v7
    v_lshl_add_u32 v7, v6, 8, v7
    v_add_u32 v7, 8388608, v7
    s_waitcnt lgkmcnt(0)
    v_lshl_add_u32 v7, v4, 11, v7
    s_lshl_b32 s56, s36, 7
    s_lshl_b32 s57, s38, 3
    s_add_u32 s56, s56, s57
    s_add_u32 s56, s56, 114688
    v_mov_b32 v4, s56
L_pollr:
    buffer_load_dwordx4 v[134:137], v7, s[64:67], 0 offen sc1
    buffer_load_dwordx4 v[138:141], v7, s[64:67], 0 offen offset:128 sc1
    s_waitcnt vmcnt(0)
    v_xor_b32 v135, s39, v135
    v_xor_b32 v137, s39, v137
    v_xor_b32 v139, s39, v139
    v_xor_b32 v141, s39, v141
    v_or3_b32 v135, v135, v137, v139
    v_or_b32 v135, v135, v141
    v_cmp_ne_u32 vcc, 0, v135
    s_sub_u32 s42, s42, 1
    s_cselect_b64 vcc, 0, vcc
    s_cselect_b32 s42, 0, s42
    s_cbranch_vccnz L_pollr
    v_mov_b32 v182, 0
    v_dot2_f32_bf16 v182, v134, v130, v182
    v_dot2_f32_bf16 v182, v136, v131, v182
    v_dot2_f32_bf16 v182, v138, v132, v182
    v_dot2_f32_bf16 v182, v140, v133, v182
    s_nop 2
    v_add_f32_dpp v182, v182, v182 quad_perm:[1,0,3,2] row_mask:0xf bank_mask:0xf
    s_nop 1
    v_add_f32_dpp v182, v182, v182 quad_perm:[2,3,0,1] row_mask:0xf bank_mask:0xf
    s_nop 1
    v_add_f32_dpp v182, v182, v182 row_half_mirror row_mask:0xf bank_mask:0xf
    s_nop 1
    v_add_f32_dpp v182, v182, v182 row_ror:8 row_mask:0xf bank_mask:0xf
    v_mov_b32 v183, v182
    s_nop 1
    v_permlane16_swap_b32 v183, v182
    v_add_f32 v182, v182, v183
    v_mov_b32 v183, v182
    s_nop 1
    v_permlane32_swap_b32 v183, v182
    v_add_f32 v182, v182, v183
    v_cvt_pk_bf16_f32 v182, 0, v182
    v_mul_f32 v182, 0xbfb8aa3b, v182
    v_exp_f32 v182, v182
    s_nop 0
    v_add_f32 v182, 1.0, v182
    v_rcp_f32 v182, v182
    s_nop 0
    v_cvt_pk_bf16_f32 v182, 0, v182
    v_mov_b32 v183, s39
    s_mov_b64 exec, 1
    s_cmp_eq_u32 s40, 1
    s_cbranch_scc0 L_slow7
    buffer_store_dwordx2 v[182:183], v4, s[64:67], 0 offen
L_back7:
    s_mov_b64 exec, -1
L_red:
    s_cmp_lg_u32 s38, 1
    s_cbranch_scc1 L_outlate
    v_lshl_add_u32 v4, v1, 4, s17
    v_mov_b32 v178, 0
    v_mov_b32 v179, 0
    v_mov_b32 v180, 0
    v_mov_b32 v181, s39
    s_and_b32 s56, s37, 3
    s_and_b32 s57, s37, 28
    v_mov_b32 v7, s57
    ds_read_b32 v244, v7 offset:4096
    s_lshl_b32 s59, s57, 9
    s_add_u32 s59, s59, 163840
    s_lshl_b32 s57, s57, 1
    s_lshl_b32 s60, s36, 7
    s_add_u32 s57, s57, s60
    s_add_u32 s57, s57, 114688
    v_mov_b32 v245, s57
    v_and_b32 v5, 3, v0
    v_lshlrev_b32 v5, 2, v5
    v_lshrrev_b32 v6, 5, v1
    v_lshl_add_u32 v5, v6, 1, v5
    v_bfe_u32 v6, v0, 4, 1
    s_lshl_b32 s60, s56, 4
    v_add_u32 v5, s60, v5
    v_add_u32 v7, v5, v6
    v_lshlrev_b32 v240, 2, v7
    ds_read_b32 v241, v240 offset:1280
    v_lshrrev_b32 v240, 3, v5
    v_lshlrev_b32 v240, 4, v240
    v_bfe_u32 v242, v5, 2, 1
    v_lshl_add_u32 v240, v242, 7, v240
    v_bfe_u32 v242, v5, 1, 1
    v_lshl_add_u32 v240, v242, 3, v240
    s_lshl_b32 s61, s36, 8
    s_add_u32 s61, s61, s59
    v_add_u32 v5, s61, v240
    v_add_u32 v242, 16384, v5
    s_lshl_b32 s61, s36, 8
    s_add_u32 s61, s61, 8388608
    v_add_u32 v5, s61, v240
    s_lshl_b32 s60, s36, 7
    v_lshl_add_u32 v243, v7, 1, s60
    v_lshlrev_b32 v6, 4, v6
    v_sub_u32 v6, 16, v6
    s_mov_b32 s58, 0x0004000c
    s_mov_b32 s59, 0x0402010c
    s_waitcnt lgkmcnt(0)
    v_lshl_add_u32 v243, v244, 10, v243
    v_lshl_add_u32 v5, v244, 11, v5
L_polls:
    buffer_load_dwordx2 v[142:143], v5, s[64:67], 0 offen sc1
    buffer_load_dwordx2 v[144:145], v242, s[64:67], 0 offen sc1
    buffer_load_dwordx2 v[182:183], v245, s[64:67], 0 offen sc1
    s_waitcnt vmcnt(0)
    v_xor_b32 v143, s39, v143
    v_xor_b32 v145, s39, v145
    v_xor_b32 v183, s39, v183
    v_or3_b32 v143, v143, v145, v183
    v_cmp_ne_u32 vcc, 0, v143
    s_sub_u32 s42, s42, 1
    s_cselect_b64 vcc, 0, vcc
    s_cselect_b32 s42, 0, s42
    s_cbranch_vccnz L_polls
    v_lshlrev_b32 v142, v6, v142
    v_and_b32 v142, s52, v142
    v_lshlrev_b32 v144, v6, v144
    v_and_b32 v144, s52, v144
    s_mov_b64 s[44:45], -1
    s_mov_b64 s[46:47], -1
    s_mov_b64 s[48:49], -1
    s_mov_b32 s50, -1
    s_mov_b32 s51, 0
L_pollp:
    s_mov_b64 exec, s[44:45]
    s_cbranch_execz L_pollp_s0
    buffer_load_dwordx4 v[166:169], v4, s[64:67], 0 offen offset:0 sc1
L_pollp_s0:
    s_mov_b64 exec, s[46:47]
    s_cbranch_execz L_pollp_s1
    buffer_load_dwordx4 v[170:173], v4, s[64:67], 0 offen offset:1024 sc1
L_pollp_s1:
    s_mov_b64 exec, s[48:49]
    s_cbranch_execz L_pollp_s2
    buffer_load_dwordx4 v[174:177], v4, s[64:67], 0 offen offset:2048 sc1
L_pollp_s2:
    s_mov_b64 exec, s[50:51]
    s_cbranch_execz L_pollp_s3
    buffer_load_dwordx4 v[178:181], v4, s[64:67], 0 offen offset:3072 sc1
L_pollp_s3:
    s_mov_b64 exec, -1
    s_waitcnt vmcnt(0)
    v_cmp_ne_u32 s[44:45], s39, v169
    v_cmp_ne_u32 s[46:47], s39, v173
    v_cmp_ne_u32 s[48:49], s39, v177
    v_cmp_ne_u32 s[50:51], s39, v181
    s_or_b64 vcc, s[44:45], s[46:47]
    s_or_b64 vcc, vcc, s[48:49]
    s_or_b64 vcc, vcc, s[50:51]
    s_sub_u32 s42, s42, 1
    s_cselect_b64 vcc, 0, vcc
    s_cselect_b32 s42, 0, s42
    s_cbranch_vccnz L_pollp
    v_perm_b32 v169, v167, v166, s58
    v_perm_b32 v173, v171, v170, s58
    v_perm_b32 v177, v175, v174, s58
    v_perm_b32 v181, v179, v178, s58
    v_perm_b32 v169, v168, v169, s59
    v_perm_b32 v173, v172, v173, s59
    v_perm_b32 v177, v176, v177, s59
    v_perm_b32 v181, v180, v181, s59
    v_pk_add_f32 v[166:167], v[166:167], v[170:171]
    v_pk_add_f32 v[168:169], v[168:169], v[172:173]
    v_pk_add_f32 v[174:175], v[174:175], v[178:179]
    v_pk_add_f32 v[176:177], v[176:177], v[180:181]
    v_pk_add_f32 v[166:167], v[166:167], v[174:175]
    v_pk_add_f32 v[168:169], v[168:169], v[176:177]
    s_nop 1
    v_permlane32_swap_b32 v166, v168
    v_permlane32_swap_b32 v167, v169
    v_add_f32 v166, v166, v168
    v_add_f32 v167, v167, v169
    s_nop 1
    v_permlane16_swap_b32 v166, v167
    v_add_f32 v166, v166, v167
    s_nop 1
    v_add_f32_dpp v166, v166, v166 row_ror:8 row_mask:0xf bank_mask:0xf
    s_nop 1
    v_add_f32_dpp v166, v166, v166 row_ror:4 row_mask:0xf bank_mask:0xf
    v_cvt_pk_bf16_f32 v166, 0, v166
    v_mul_f32 v166, v166, v182
    v_cvt_pk_bf16_f32 v166, 0, v166
    v_add_f32 v166, v166, v142
    v_cvt_pk_bf16_f32 v166, 0, v166
    v_mul_f32 v166, v166, v241
    v_cvt_pk_bf16_f32 v166, 0, v166
    v_add_f32 v166, v166, v144
    v_cvt_pk_bf16_f32 v166, v166, v166
    s_mov_b32 s56, 0x000f000f
    s_mov_b32 s57, 0x000f000f
    s_mov_b64 exec, s[56:57]
    buffer_store_short v166, v243, s[68:71], 0 offen
    s_mov_b64 exec, -1
L_outlate:
L_fin:
L_end:
    s_endpgm
L_slow1:
    s_nop 4
    buffer_store_dword v3, v6, s[64:67], 0 offen sc1
    s_nop 1
    s_branch L_back1
L_slow2:
    s_nop 4
    buffer_store_dwordx2 v[204:205], v4, s[64:67], 0 offen sc1
    s_nop 1
    s_branch L_back2
L_slow3:
    s_nop 4
    buffer_store_dwordx4 v[152:155], v6, s[64:67], 0 offen sc1
    s_nop 1
    s_branch L_back3
L_slow4:
    s_nop 4
    buffer_store_dword v3, v5, s[64:67], 0 offen sc1
    s_nop 1
    s_branch L_back4
L_slow5:
    s_nop 4
    buffer_store_dwordx2 v[92:93], v4, s[64:67], 0 offen sc1
    s_nop 1
    s_branch L_back5
L_slow6:
    s_nop 4
    buffer_store_dwordx4 v[182:185], v143, s[64:67], 0 offen sc1
    buffer_store_dwordx4 v[186:189], v143, s[64:67], 0 offen offset:512 sc1
    s_nop 1
    s_branch L_back6
L_slow7:
    s_nop 4
    buffer_store_dwordx2 v[182:183], v4, s[64:67], 0 offen sc1
    s_nop 1
    s_branch L_back7
L_modeslow:
    s_mov_b32 s3, 64
L_moderetry:
    buffer_load_dword v38, v40, s[64:67], 0 offen sc1
    s_waitcnt vmcnt(0)
    s_mov_b32 s40, 1
    v_cmp_ne_u32 vcc, s41, v38
    s_cbranch_vccz L_modeback
    s_mov_b32 s40, 0
    v_subrev_u32 v39, s39, v38
    v_subrev_u32 v39, 1, v39
    v_cmp_lt_u32 vcc, 15, v39
    s_cbranch_vccz L_modeback
    s_sub_u32 s3, s3, 1
    s_cbranch_scc0 L_moderetry
    s_branch L_modeback
L_x1slow:
    buffer_store_dwordx4 v[92:95], v96, s[64:67], 0 offen sc1
    s_waitcnt vmcnt(0)
    s_branch L_x1back
L_wr1a:
    s_waitcnt vmcnt(3)
    s_branch L_wr1b
L_wr2a:
    s_cmp_eq_u32 s16, 2
    s_cbranch_scc1 L_wr2c
    s_waitcnt vmcnt(1)
    s_branch L_wr2b
L_wr2c:
    s_waitcnt vmcnt(7)
    s_branch L_wr2b
L_wr3a:
    s_cmp_eq_u32 s16, 2
    s_cbranch_scc1 L_wr3c
    s_waitcnt vmcnt(2)
    s_branch L_wr3b
L_wr3c:
    s_waitcnt vmcnt(63)
    s_branch L_wr3b
L_pollx0:
L_pollx0b:
    buffer_load_dwordx4 v[220:223], v57, s[64:67], 0 offen sc1
    s_waitcnt vmcnt(0)
    v_xor_b32 v221, s39, v221
    v_xor_b32 v223, s39, v223
    v_or_b32 v221, v221, v223
    v_cmp_ne_u32 vcc, 0, v221
    s_sub_u32 s42, s42, 1
    s_cselect_b64 vcc, 0, vcc
    s_cselect_b32 s42, 0, s42
    s_cbranch_vccnz L_pollx0b
    s_nop 1
    s_branch L_pollx0_back
L_pollm:
L_pollmb:
    buffer_load_dwordx4 v[140:143], v56, s[64:67], 0 offen offset:0 sc1
    buffer_load_dwordx4 v[144:147], v56, s[64:67], 0 offen offset:1024 sc1
    s_waitcnt vmcnt(0)
    v_xor_b32 v141, s39, v141
    v_xor_b32 v143, s39, v143
    v_xor_b32 v145, s39, v145
    v_xor_b32 v147, s39, v147
    v_or3_b32 v141, v141, v143, v145
    v_or_b32 v141, v141, v147
    v_cmp_ne_u32 vcc, 0, v141
    s_sub_u32 s42, s42, 1
    s_cselect_b64 vcc, 0, vcc
    s_cselect_b32 s42, 0, s42
    s_cbranch_vccnz L_pollmb
    s_branch L_pollm_back
L_pollc:
L_pollcb:
    buffer_load_dwordx4 v[50:53], v48, s[64:67], 0 offen sc1
    s_waitcnt vmcnt(0)
    v_xor_b32 v6, s39, v51
    v_xor_b32 v7, s39, v53
    v_or_b32 v6, v6, v7
    v_cmp_ne_u32 vcc, 0, v6
    s_sub_u32 s42, s42, 1
    s_cselect_b64 vcc, 0, vcc
    s_cselect_b32 s42, 0, s42
    s_cbranch_vccnz L_pollcb
    s_branch L_pollc_back
L_poll3:
L_poll3b:
    buffer_load_dwordx4 v[92:95], v99, s[64:67], 0 offen sc1
    s_waitcnt vmcnt(0)
    v_cmp_ne_u32 vcc, s39, v95
    s_sub_u32 s42, s42, 1
    s_cselect_b64 vcc, 0, vcc
    s_cselect_b32 s42, 0, s42
    s_cbranch_vccnz L_poll3b
    s_nop 1
    s_branch L_poll3_back
L_noout3:
    s_waitcnt vmcnt(0)
    s_branch L_noout2
L_pollg:
L_pollgb:
    buffer_load_dwordx4 v[166:169], v142, s[64:67], 0 offen sc1
    s_waitcnt vmcnt(0)
    v_xor_b32 v167, s39, v167
    v_xor_b32 v169, s39, v169
    v_or_b32 v167, v167, v169
    v_cmp_ne_u32 vcc, 0, v167
    s_sub_u32 s42, s42, 1
    s_cselect_b64 vcc, 0, vcc
    s_cselect_b32 s42, 0, s42
    s_cbranch_vccnz L_pollgb
    s_branch L_pollg_back
L_codeend:
.section .rodata,"a"
.p2align 6
.amdhsa_kernel adaLN_cond__ssm_conv_h3__moe_arch_mod__prompt_kernel
  .amdhsa_next_free_vgpr 248
  .amdhsa_next_free_sgpr 102
  .amdhsa_accum_offset 248
  .amdhsa_group_segment_fixed_size 0
  .amdhsa_kernarg_size 128
  .amdhsa_user_sgpr_count 2
  .amdhsa_user_sgpr_kernarg_segment_ptr 1
  .amdhsa_system_sgpr_workgroup_id_x 1
.end_amdhsa_kernel
```
